```python
import torch

def _softmax(x, axis=-1):
    return torch.softmax(x, dim=axis)
def _gelu(x):
    return torch.nn.functional.gelu(x, approximate="tanh")
def _silu(x):
    return torch.nn.functional.silu(x)
def _sigmoid(x):
    return torch.sigmoid(x)
def _layernorm(x, axis=-1, eps=1e-5):
    m = x.mean(dim=axis, keepdim=True)
    v = x.var(dim=axis, keepdim=True, unbiased=False)
    return (x - m) / torch.sqrt(v + eps)
def _scatter_add(tgt, idx, src, axis=0):
    return tgt.clone().index_add_(axis, idx, src)
def _segment_sum(src, seg, n):
    out = torch.zeros((n,) + src.shape[1:], dtype=src.dtype)
    return out.index_add_(0, seg, src)
def _pad(x, pw):
    flat = tuple(v for pair in reversed(pw) for v in pair)
    return torch.nn.functional.pad(x, flat)

kernel_name = 'parallel_sum__spectral_fnet__geglu_ffn__prompt'

def setup_inputs():

    _w = (lambda a: (lambda t: t.to(torch.bfloat16) if t.is_floating_point() else t)(torch.as_tensor(a)))
    def _A_setup():
        B, S, D = 1, 2048, 512
        ns = torch.arange(S)[:, None] * torch.arange(S)[None, :]
        nd = torch.arange(D)[:, None] * torch.arange(D)[None, :]
        Ws_re = torch.cos(-2.0 * torch.pi * ns / S).to(float)
        Ws_im = torch.sin(-2.0 * torch.pi * ns / S).to(float)
        Wd_re = torch.cos(-2.0 * torch.pi * nd / D).to(float)
        Wd_im = torch.sin(-2.0 * torch.pi * nd / D).to(float)
        return {
            "x": _w((lambda *s: torch.randn(*s, dtype=torch.bfloat16) * 0.05)(B, S, D)),
            "dft_seq_re": _w(Ws_re),
            "dft_seq_im": _w(Ws_im),
            "dft_hid_re": _w(Wd_re),
            "dft_hid_im": _w(Wd_im),
        }
    _A_in = _A_setup()

    def _B_setup():
        B, S, D, F = 1, 2048, 512, 1792
        return {
            "x": _w((lambda *s: torch.randn(*s, dtype=torch.bfloat16) * 0.05)(B, S, D)),
            "w_gate": _w((lambda *s: torch.randn(*s, dtype=torch.bfloat16) * 0.2)(D, F)),
            "w_up": _w((lambda *s: torch.randn(*s, dtype=torch.bfloat16) * 0.2)(D, F)),
            "w_down": _w((lambda *s: torch.randn(*s, dtype=torch.bfloat16) * 0.2)(F, D)),
        }
    _B_in = _B_setup()

    return {
        "A_x": _A_in["x"],
        "A_dft_seq_re": _A_in["dft_seq_re"],
        "A_dft_seq_im": _A_in["dft_seq_im"],
        "A_dft_hid_re": _A_in["dft_hid_re"],
        "A_dft_hid_im": _A_in["dft_hid_im"],
        "B_x": _B_in["x"],
        "B_w_gate": _B_in["w_gate"],
        "B_w_up": _B_in["w_up"],
        "B_w_down": _B_in["w_down"],
    }

def reference(A_x, A_dft_seq_re, A_dft_seq_im, A_dft_hid_re, A_dft_hid_im, B_x, B_w_gate, B_w_up, B_w_down):
    def _A_ref(x, dft_seq_re, dft_seq_im, dft_hid_re, dft_hid_im):
        a = torch.einsum("bsd,ed->bse", x, dft_hid_re)
        b = torch.einsum("bsd,ed->bse", x, dft_hid_im)
        y = torch.einsum("ts,bse->bte", dft_seq_re, a) - torch.einsum("ts,bse->bte", dft_seq_im, b)
        return y

    def _B_ref(x, w_gate, w_up, w_down):
        return (_gelu(x @ w_gate) * (x @ w_up)) @ w_down

    x = A_x
    xn = _layernorm(x, axis=-1)
    return x + _A_ref(xn, A_dft_seq_re, A_dft_seq_im, A_dft_hid_re, A_dft_hid_im) + _B_ref(xn, B_w_gate, B_w_up, B_w_down)
```

```asm
; @launch kernel=fnet_g1_kernel grid=(256,1,1) block=(512,1,1) lds=163840
; @launch kernel=fnet_g2_kernel grid=(256,1,1) block=(512,1,1) lds=139264
.amdgcn_target "amdgcn-amd-amdhsa--gfx950"
.text
.globl fnet_g1_kernel
.p2align 8
.type fnet_g1_kernel,@function
fnet_g1_kernel:
 s_cmp_ge_u32 s2, 256
 s_cbranch_scc1 K1_END
 s_load_dwordx2 s[4:5], s[0:1], 0
 s_load_dwordx4 s[12:15], s[0:1], 48
 s_load_dwordx2 s[16:17], s[0:1], 64
 s_load_dwordx4 s[72:75], s[0:1], 80
 v_lshrrev_b32 v2, 6, v0
 v_and_b32 v1, 63, v0
 s_mov_b32 s40, 0xffff0000
 v_readfirstlane_b32 s20, v2
 s_and_b32 s21, s2, 7
 s_lshr_b32 s22, s2, 3
 s_lshr_b32 s27, s20, 2
 s_and_b32 s28, s20, 3
 v_and_b32 v20, 3, v1
 v_lshrrev_b32 v21, 2, v1
 v_lshrrev_b32 v22, 4, v1
 v_lshrrev_b32 v26, 3, v1
 v_and_b32 v27, 7, v1
 v_lshlrev_b32 v25, 4, v1
 s_mov_b32 s46, 0x200000
 s_mov_b32 s47, 0x20000
 s_cmp_lt_u32 s22, 4
 s_cbranch_scc1 K1_FFT
 s_sub_u32 s22, s22, 4
 s_and_b32 s23, s21, 3
 s_lshl_b32 s23, s23, 2
 s_and_b32 s3, s22, 3
 s_add_u32 s23, s23, s3
 s_lshr_b32 s24, s21, 2
 s_mul_i32 s24, s24, 7
 s_lshr_b32 s3, s22, 2
 s_add_u32 s24, s24, s3
 s_lshl_b32 s83, s24, 8
 s_cmp_lg_u32 s27, 0
 s_cbranch_scc1 K1_FB
 s_lshl_b32 s3, s23, 6
 s_and_b32 s31, s28, 1
 s_lshl_b32 s31, s31, 4
 s_add_u32 s3, s3, s31
 v_add_u32 v31, s3, v26
 s_bitcmp1_b32 s28, 1
 s_cselect_b32 s3, -1, 0
 v_xor_b32 v31, s3, v31
 v_xor_b32 v8, v27, v22
 v_lshlrev_b32 v8, 4, v8
 s_cselect_b32 s3, 2049, 0
 v_add_u32 v2, s3, v31
 v_mov_b32 v4, 0x400
 v_cmp_eq_u32 vcc, 0x800, v2
 s_nop 1
 v_cndmask_b32 v2, v2, v4, vcc
 v_lshl_add_u32 v2, v2, 10, v8
 s_cselect_b32 s3, 2041, 8
 v_add_u32 v3, s3, v31
 v_lshl_add_u32 v3, v3, 10, v8
 v_xor_b32 v3, 64, v3
 s_lshr_b32 s31, s28, 1
 s_lshl_b32 s31, s31, 7
 s_add_u32 s3, s83, s31
 s_and_b32 s31, s28, 1
 s_mul_i32 s31, s31, 57344
 s_add_u32 s3, s3, s31
 v_mul_u32_u24 v4, 3584, v26
 v_and_b32 v8, 1, v22
 v_lshlrev_b32 v8, 2, v8
 v_xor_b32 v8, v8, v27
 v_lshlrev_b32 v8, 4, v8
 v_add3_u32 v4, v4, v8, s3
 v_add_u32 v8, 28672, v4
 s_lshl_b32 s25, s28, 11
 s_add_u32 s30, s25, 49152
 s_mov_b32 s50, 1835008
 s_mov_b32 s51, 0x20000
 s_waitcnt lgkmcnt(0)
 s_mov_b32 s44, s4
 s_mov_b32 s45, s5
 s_mov_b32 s48, s12
 s_mov_b32 s49, s13
 s_add_u32 m0, s25, 0
 s_mov_b32 s26, 0
 buffer_load_dwordx4 v2, s[44:47], s26 offen lds
 s_add_u32 m0, s25, 1024
 s_mov_b32 s26, 0
 buffer_load_dwordx4 v3, s[44:47], s26 offen lds
 s_add_u32 m0, s30, 0
 s_mov_b32 s37, 0
 buffer_load_dwordx4 v4, s[48:51], s37 offen lds
 s_add_u32 m0, s30, 1024
 s_nop 0
 buffer_load_dwordx4 v8, s[48:51], s37 offen lds
 v_lshrrev_b32 v23, 5, v1
 v_and_b32 v24, 31, v1
 v_lshrrev_b32 v14, 1, v24
 v_and_b32 v14, 7, v14
 v_xor_b32 v14, v14, v23
 v_lshlrev_b32 v14, 4, v14
 v_lshlrev_b32 v15, 7, v24
 s_lshl_b32 s3, s27, 13
 v_add3_u32 v14, v14, v15, s3
 v_xor_b32 v15, 32, v14
 v_xor_b32 v16, 64, v14
 v_xor_b32 v17, 0x60, v14
 v_and_b32 v29, 3, v21
 v_and_b32 v5, 1, v22
 v_lshlrev_b32 v5, 5, v5
 v_lshl_add_u32 v6, v20, 3, v5
 v_lshlrev_b32 v5, 7, v29
 v_lshl_add_u32 v5, v23, 10, v5
 v_lshl_add_u32 v29, v29, 6, v6
 v_add_u32 v5, v5, v6
 v_and_b32 v6, 1, v26
 s_and_b32 s3, s28, 1
 v_xor_b32 v6, s3, v6
 v_lshlrev_b32 v6, 6, v6
 s_lshr_b32 s3, s28, 1
 s_lshl_b32 s3, s3, 12
 s_add_u32 s3, s3, 49152
 v_add3_u32 v5, v5, v6, s3
 v_add_u32 v6, 49152, v5
 s_lshl_b32 s76, s2, 3
 s_lshl_b32 s3, s28, 1
 s_add_u32 s76, s76, s3
 s_lshl_b32 s77, s76, 4
 s_add_u32 s77, s77, 65536
 s_lshl_b32 s76, s76, 10
 v_and_b32 v12, 1, v26
 v_lshlrev_b32 v12, 10, v12
 v_lshl_add_u32 v12, v27, 6, v12
 v_lshl_add_u32 v12, v22, 4, v12
 buffer_load_dwordx4 v[128:131], v12, s[44:47], s76 offen
 buffer_load_dwordx4 v[132:135], v12, s[44:47], s76 offen offset:512
 s_add_u32 m0, s30, 16384
 s_mov_b32 s37, 114688
 buffer_load_dwordx4 v4, s[48:51], s37 offen lds
 s_add_u32 m0, s30, 17408
 s_nop 0
 buffer_load_dwordx4 v8, s[48:51], s37 offen lds
 s_add_u32 m0, s25, 16384
 s_mov_b32 s26, 128
 buffer_load_dwordx4 v2, s[44:47], s26 offen lds
 s_add_u32 m0, s25, 17408
 s_mov_b32 s26, 128
 buffer_load_dwordx4 v3, s[44:47], s26 offen lds
 s_mov_b32 s18, s74
 s_mov_b32 s19, s75
 s_mov_b32 s52, s18
 s_mov_b32 s53, s19
 s_mov_b32 s54, 7340032
 s_mov_b32 s55, 0x20000
 s_add_u32 s68, s18, 15728640
 s_addc_u32 s69, s19, 0
 s_mov_b32 s70, 196608
 s_mov_b32 s71, 0x20000
 s_load_dwordx2 s[66:67], s[68:69], 0
 v_mov_b32 v172, 0x3f803f80
 v_mov_b32 v173, 0x3f803f80
 v_mov_b32 v174, 0x3f803f80
 v_mov_b32 v175, 0x3f803f80
 v_and_b32 v19, 3, v21
 v_cmp_eq_u32 s[60:61], v19, v22
 v_cmp_eq_u32 s[80:81], 1, v20
 v_cmp_lt_u32 s[58:59], 1, v20
 v_cmp_eq_u32 s[56:57], 3, v20
 v_mov_b32 v19, 0x1000000
 v_cmp_eq_u32 vcc, 0, v1
 s_nop 1
 v_cndmask_b32 v13, v19, 0, vcc
 v_cmp_eq_u32 vcc, 40, v1
 s_nop 1
 v_cndmask_b32 v13, v13, 16, vcc
 s_waitcnt lgkmcnt(0)
 s_add_u32 s66, s66, 1
 s_addc_u32 s67, s67, 0
 s_waitcnt vmcnt(6)
 s_barrier
 ds_read_b128 v[32:35], v14 offset:0
 ds_read_b64_tr_b16 v[40:41], v5 offset:0
 ds_read_b64_tr_b16 v[42:43], v5 offset:512
 ds_read_b64_tr_b16 v[44:45], v5 offset:8192
 ds_read_b64_tr_b16 v[46:47], v5 offset:8704
 ds_read_b128 v[36:39], v14 offset:4096
 s_waitcnt lgkmcnt(3)
 v_mfma_f32_32x32x16_bf16 v[64:79], v[40:43], v[32:35], 0
 ds_read_b128 v[48:51], v15 offset:0
 ds_read_b64_tr_b16 v[56:57], v5 offset:2048
 ds_read_b64_tr_b16 v[58:59], v5 offset:2560
 ds_read_b64_tr_b16 v[60:61], v5 offset:10240
 ds_read_b64_tr_b16 v[62:63], v5 offset:10752
 ds_read_b128 v[52:55], v15 offset:4096
 s_waitcnt lgkmcnt(7)
 v_mfma_f32_32x32x16_bf16 v[80:95], v[44:47], v[32:35], 0
 s_add_u32 m0, s30, 32768
 s_mov_b32 s37, 229376
 buffer_load_dwordx4 v4, s[48:51], s37 offen lds
 s_waitcnt lgkmcnt(6)
 v_mfma_f32_32x32x16_bf16 v[96:111], v[40:43], v[36:39], 0
 s_add_u32 m0, s30, 33792
 s_nop 0
 buffer_load_dwordx4 v8, s[48:51], s37 offen lds
 v_mfma_f32_32x32x16_bf16 v[112:127], v[44:47], v[36:39], 0
 s_waitcnt vmcnt(4) lgkmcnt(0)
 s_barrier
 v_mfma_f32_32x32x16_bf16 v[64:79], v[56:59], v[48:51], v[64:79]
 ds_read_b128 v[32:35], v16 offset:0
 ds_read_b64_tr_b16 v[40:41], v5 offset:16384
 ds_read_b64_tr_b16 v[42:43], v5 offset:16896
 ds_read_b64_tr_b16 v[44:45], v5 offset:24576
 ds_read_b64_tr_b16 v[46:47], v5 offset:25088
 ds_read_b128 v[36:39], v16 offset:4096
 v_mfma_f32_32x32x16_bf16 v[80:95], v[60:63], v[48:51], v[80:95]
 s_add_u32 m0, s30, 49152
 s_mov_b32 s37, 344064
 buffer_load_dwordx4 v4, s[48:51], s37 offen lds
 v_mfma_f32_32x32x16_bf16 v[96:111], v[56:59], v[52:55], v[96:111]
 s_add_u32 m0, s30, 50176
 s_nop 0
 buffer_load_dwordx4 v8, s[48:51], s37 offen lds
 v_mfma_f32_32x32x16_bf16 v[112:127], v[60:63], v[52:55], v[112:127]
 s_waitcnt lgkmcnt(3)
 v_mfma_f32_32x32x16_bf16 v[64:79], v[40:43], v[32:35], v[64:79]
 ds_read_b128 v[48:51], v17 offset:0
 ds_read_b64_tr_b16 v[56:57], v5 offset:18432
 ds_read_b64_tr_b16 v[58:59], v5 offset:18944
 ds_read_b64_tr_b16 v[60:61], v5 offset:26624
 ds_read_b64_tr_b16 v[62:63], v5 offset:27136
 ds_read_b128 v[52:55], v17 offset:4096
 v_mfma_f32_16x16x32_bf16 v[136:139], v[172:175], v[128:131], 0
 s_waitcnt lgkmcnt(7)
 v_mfma_f32_32x32x16_bf16 v[80:95], v[44:47], v[32:35], v[80:95]
 s_add_u32 m0, s25, 32768
 s_mov_b32 s26, 256
 buffer_load_dwordx4 v2, s[44:47], s26 offen lds
 v_mfma_f32_16x16x32_bf16 v[140:143], v[128:131], v[128:131], 0
 s_waitcnt lgkmcnt(6)
 v_mfma_f32_32x32x16_bf16 v[96:111], v[40:43], v[36:39], v[96:111]
 s_add_u32 m0, s25, 33792
 s_mov_b32 s26, 256
 buffer_load_dwordx4 v3, s[44:47], s26 offen lds
 v_mfma_f32_16x16x32_bf16 v[136:139], v[172:175], v[132:135], v[136:139]
 v_mfma_f32_32x32x16_bf16 v[112:127], v[44:47], v[36:39], v[112:127]
 v_mfma_f32_16x16x32_bf16 v[140:143], v[132:135], v[132:135], v[140:143]
 s_waitcnt vmcnt(4) lgkmcnt(0)
 s_barrier
 v_mfma_f32_32x32x16_bf16 v[64:79], v[56:59], v[48:51], v[64:79]
 ds_read_b128 v[32:35], v14 offset:16384
 ds_read_b64_tr_b16 v[40:41], v5 offset:32768
 ds_read_b64_tr_b16 v[42:43], v5 offset:33280
 ds_read_b64_tr_b16 v[44:45], v5 offset:40960
 ds_read_b64_tr_b16 v[46:47], v5 offset:41472
 ds_read_b128 v[36:39], v14 offset:20480
 v_cndmask_b32 v140, v140, v141, s[80:81]
 v_cndmask_b32 v142, v142, v143, s[56:57]
 v_add_f32_dpp v136, v136, v136 quad_perm:[1,0,3,2] row_mask:0xf bank_mask:0xf
 v_cndmask_b32 v140, v140, v142, s[58:59]
 v_mfma_f32_32x32x16_bf16 v[80:95], v[60:63], v[48:51], v[80:95]
 s_add_u32 m0, s30, 65536
 s_mov_b32 s37, 458752
 buffer_load_dwordx4 v4, s[48:51], s37 offen lds
 v_add_f32_dpp v136, v136, v136 quad_perm:[2,3,0,1] row_mask:0xf bank_mask:0xf
 v_cndmask_b32 v140, 0, v140, s[60:61]
 s_nop 0
 v_add_f32_dpp v136, v136, v136 row_half_mirror row_mask:0xf bank_mask:0xf
 v_add_f32_dpp v140, v140, v140 row_ror:8 row_mask:0xf bank_mask:0xf
 v_mfma_f32_32x32x16_bf16 v[96:111], v[56:59], v[52:55], v[96:111]
 s_add_u32 m0, s30, 66560
 s_nop 0
 buffer_load_dwordx4 v8, s[48:51], s37 offen lds
 v_add_f32_dpp v140, v140, v140 row_ror:4 row_mask:0xf bank_mask:0xf
 s_nop 1
 v_add_f32_dpp v140, v140, v140 row_ror:2 row_mask:0xf bank_mask:0xf
 s_nop 1
 v_add_f32_dpp v140, v140, v140 row_ror:1 row_mask:0xf bank_mask:0xf
 v_mov_b32 v141, v140
 v_mfma_f32_32x32x16_bf16 v[112:127], v[60:63], v[52:55], v[112:127]
 s_nop 0
 v_permlane16_swap_b32 v140, v141
 v_add_f32 v140, v140, v141
 v_mul_f32 v164, 0x3b000000, v136
 v_mul_f32 v166, 0x3b000000, v140
 s_waitcnt lgkmcnt(3)
 v_mfma_f32_32x32x16_bf16 v[64:79], v[40:43], v[32:35], v[64:79]
 ds_read_b128 v[48:51], v15 offset:16384
 ds_read_b64_tr_b16 v[56:57], v5 offset:34816
 ds_read_b64_tr_b16 v[58:59], v5 offset:35328
 ds_read_b64_tr_b16 v[60:61], v5 offset:43008
 ds_read_b64_tr_b16 v[62:63], v5 offset:43520
 ds_read_b128 v[52:55], v15 offset:20480
 v_fma_f32 v166, -v164, v164, v166
 v_max_f32 v166, 0, v166
 v_cvt_pk_bf16_f32 v167, v164, v166
 v_lshlrev_b32 v164, 16, v167
 s_waitcnt lgkmcnt(7)
 v_mfma_f32_32x32x16_bf16 v[80:95], v[44:47], v[32:35], v[80:95]
 s_add_u32 m0, s30, 81920
 s_mov_b32 s37, 573440
 buffer_load_dwordx4 v4, s[48:51], s37 offen lds
 v_and_b32 v166, s40, v167
 v_add_f32 v166, 0x3727c5ac, v166
 v_cvt_pk_bf16_f32 v166, v166, v166
 v_and_b32 v166, s40, v166
 s_waitcnt lgkmcnt(6)
 v_mfma_f32_32x32x16_bf16 v[96:111], v[40:43], v[36:39], v[96:111]
 s_add_u32 m0, s30, 82944
 s_nop 0
 buffer_load_dwordx4 v8, s[48:51], s37 offen lds
 v_sqrt_f32 v166, v166
 s_nop 0
 v_cvt_pk_bf16_f32 v166, v166, v166
 v_and_b32 v166, s40, v166
 v_rcp_f32 v165, v166
 v_mfma_f32_32x32x16_bf16 v[112:127], v[44:47], v[36:39], v[112:127]
 v_mov_b32 v166, s66
 v_mov_b32 v167, s67
 buffer_store_dwordx4 v[164:167], v13, s[68:71], s77 offen sc1
 s_waitcnt vmcnt(7) lgkmcnt(0)
 s_barrier
 v_mfma_f32_32x32x16_bf16 v[64:79], v[56:59], v[48:51], v[64:79]
 ds_read_b128 v[32:35], v16 offset:16384
 ds_read_b64_tr_b16 v[40:41], v6 offset:0
 ds_read_b64_tr_b16 v[42:43], v6 offset:512
 ds_read_b64_tr_b16 v[44:45], v6 offset:8192
 ds_read_b64_tr_b16 v[46:47], v6 offset:8704
 ds_read_b128 v[36:39], v16 offset:20480
 v_mfma_f32_32x32x16_bf16 v[80:95], v[60:63], v[48:51], v[80:95]
 s_add_u32 m0, s25, 0
 s_mov_b32 s26, 384
 buffer_load_dwordx4 v2, s[44:47], s26 offen lds
 v_mfma_f32_32x32x16_bf16 v[96:111], v[56:59], v[52:55], v[96:111]
 s_add_u32 m0, s25, 1024
 s_mov_b32 s26, 384
 buffer_load_dwordx4 v3, s[44:47], s26 offen lds
 v_mfma_f32_32x32x16_bf16 v[112:127], v[60:63], v[52:55], v[112:127]
 s_waitcnt lgkmcnt(3)
 v_mfma_f32_32x32x16_bf16 v[64:79], v[40:43], v[32:35], v[64:79]
 ds_read_b128 v[48:51], v17 offset:16384
 ds_read_b64_tr_b16 v[56:57], v6 offset:2048
 ds_read_b64_tr_b16 v[58:59], v6 offset:2560
 ds_read_b64_tr_b16 v[60:61], v6 offset:10240
 ds_read_b64_tr_b16 v[62:63], v6 offset:10752
 ds_read_b128 v[52:55], v17 offset:20480
 s_waitcnt lgkmcnt(7)
 v_mfma_f32_32x32x16_bf16 v[80:95], v[44:47], v[32:35], v[80:95]
 s_add_u32 m0, s30, 0
 s_mov_b32 s37, 688128
 buffer_load_dwordx4 v4, s[48:51], s37 offen lds
 s_waitcnt lgkmcnt(6)
 v_mfma_f32_32x32x16_bf16 v[96:111], v[40:43], v[36:39], v[96:111]
 s_add_u32 m0, s30, 1024
 s_nop 0
 buffer_load_dwordx4 v8, s[48:51], s37 offen lds
 v_mfma_f32_32x32x16_bf16 v[112:127], v[44:47], v[36:39], v[112:127]
 s_waitcnt vmcnt(7) lgkmcnt(0)
 s_barrier
 v_mfma_f32_32x32x16_bf16 v[64:79], v[56:59], v[48:51], v[64:79]
 ds_read_b128 v[32:35], v14 offset:32768
 ds_read_b64_tr_b16 v[40:41], v6 offset:16384
 ds_read_b64_tr_b16 v[42:43], v6 offset:16896
 ds_read_b64_tr_b16 v[44:45], v6 offset:24576
 ds_read_b64_tr_b16 v[46:47], v6 offset:25088
 ds_read_b128 v[36:39], v14 offset:36864
 v_mfma_f32_32x32x16_bf16 v[80:95], v[60:63], v[48:51], v[80:95]
 s_add_u32 m0, s30, 16384
 s_mov_b32 s37, 802816
 buffer_load_dwordx4 v4, s[48:51], s37 offen lds
 v_mfma_f32_32x32x16_bf16 v[96:111], v[56:59], v[52:55], v[96:111]
 s_add_u32 m0, s30, 17408
 s_nop 0
 buffer_load_dwordx4 v8, s[48:51], s37 offen lds
 v_mfma_f32_32x32x16_bf16 v[112:127], v[60:63], v[52:55], v[112:127]
 s_waitcnt lgkmcnt(3)
 v_mfma_f32_32x32x16_bf16 v[64:79], v[40:43], v[32:35], v[64:79]
 ds_read_b128 v[48:51], v15 offset:32768
 ds_read_b64_tr_b16 v[56:57], v6 offset:18432
 ds_read_b64_tr_b16 v[58:59], v6 offset:18944
 ds_read_b64_tr_b16 v[60:61], v6 offset:26624
 ds_read_b64_tr_b16 v[62:63], v6 offset:27136
 ds_read_b128 v[52:55], v15 offset:36864
 s_waitcnt lgkmcnt(7)
 v_mfma_f32_32x32x16_bf16 v[80:95], v[44:47], v[32:35], v[80:95]
 s_add_u32 m0, s25, 16384
 s_mov_b32 s26, 512
 buffer_load_dwordx4 v2, s[44:47], s26 offen lds
 s_waitcnt lgkmcnt(6)
 v_mfma_f32_32x32x16_bf16 v[96:111], v[40:43], v[36:39], v[96:111]
 v_mfma_f32_32x32x16_bf16 v[112:127], v[44:47], v[36:39], v[112:127]
 s_waitcnt vmcnt(7) lgkmcnt(0)
 s_barrier
 v_mfma_f32_32x32x16_bf16 v[64:79], v[56:59], v[48:51], v[64:79]
 ds_read_b128 v[32:35], v16 offset:32768
 ds_read_b64_tr_b16 v[40:41], v6 offset:32768
 ds_read_b64_tr_b16 v[42:43], v6 offset:33280
 ds_read_b64_tr_b16 v[44:45], v6 offset:40960
 ds_read_b64_tr_b16 v[46:47], v6 offset:41472
 ds_read_b128 v[36:39], v16 offset:36864
 v_mfma_f32_32x32x16_bf16 v[80:95], v[60:63], v[48:51], v[80:95]
 s_add_u32 m0, s25, 17408
 s_mov_b32 s26, 512
 buffer_load_dwordx4 v3, s[44:47], s26 offen lds
 v_mfma_f32_32x32x16_bf16 v[96:111], v[56:59], v[52:55], v[96:111]
 s_add_u32 m0, s30, 32768
 s_mov_b32 s37, 917504
 buffer_load_dwordx4 v4, s[48:51], s37 offen lds
 v_mfma_f32_32x32x16_bf16 v[112:127], v[60:63], v[52:55], v[112:127]
 s_waitcnt lgkmcnt(3)
 v_mfma_f32_32x32x16_bf16 v[64:79], v[40:43], v[32:35], v[64:79]
 ds_read_b128 v[48:51], v17 offset:32768
 ds_read_b64_tr_b16 v[56:57], v6 offset:34816
 ds_read_b64_tr_b16 v[58:59], v6 offset:35328
 ds_read_b64_tr_b16 v[60:61], v6 offset:43008
 ds_read_b64_tr_b16 v[62:63], v6 offset:43520
 ds_read_b128 v[52:55], v17 offset:36864
 s_waitcnt lgkmcnt(7)
 v_mfma_f32_32x32x16_bf16 v[80:95], v[44:47], v[32:35], v[80:95]
 s_add_u32 m0, s30, 33792
 s_nop 0
 buffer_load_dwordx4 v8, s[48:51], s37 offen lds
 s_waitcnt lgkmcnt(6)
 v_mfma_f32_32x32x16_bf16 v[96:111], v[40:43], v[36:39], v[96:111]
 v_mfma_f32_32x32x16_bf16 v[112:127], v[44:47], v[36:39], v[112:127]
 s_waitcnt vmcnt(6) lgkmcnt(0)
 s_barrier
 v_mfma_f32_32x32x16_bf16 v[64:79], v[56:59], v[48:51], v[64:79]
 ds_read_b128 v[32:35], v14 offset:0
 ds_read_b64_tr_b16 v[40:41], v5 offset:0
 ds_read_b64_tr_b16 v[42:43], v5 offset:512
 ds_read_b64_tr_b16 v[44:45], v5 offset:8192
 ds_read_b64_tr_b16 v[46:47], v5 offset:8704
 ds_read_b128 v[36:39], v14 offset:4096
 v_mfma_f32_32x32x16_bf16 v[80:95], v[60:63], v[48:51], v[80:95]
 s_add_u32 m0, s30, 49152
 s_mov_b32 s37, 1032192
 buffer_load_dwordx4 v4, s[48:51], s37 offen lds
 v_mfma_f32_32x32x16_bf16 v[96:111], v[56:59], v[52:55], v[96:111]
 s_add_u32 m0, s30, 50176
 s_nop 0
 buffer_load_dwordx4 v8, s[48:51], s37 offen lds
 v_mfma_f32_32x32x16_bf16 v[112:127], v[60:63], v[52:55], v[112:127]
 s_waitcnt lgkmcnt(3)
 v_mfma_f32_32x32x16_bf16 v[64:79], v[40:43], v[32:35], v[64:79]
 ds_read_b128 v[48:51], v15 offset:0
 ds_read_b64_tr_b16 v[56:57], v5 offset:2048
 ds_read_b64_tr_b16 v[58:59], v5 offset:2560
 ds_read_b64_tr_b16 v[60:61], v5 offset:10240
 ds_read_b64_tr_b16 v[62:63], v5 offset:10752
 ds_read_b128 v[52:55], v15 offset:4096
 s_waitcnt lgkmcnt(7)
 v_mfma_f32_32x32x16_bf16 v[80:95], v[44:47], v[32:35], v[80:95]
 s_add_u32 m0, s25, 32768
 s_mov_b32 s26, 640
 buffer_load_dwordx4 v2, s[44:47], s26 offen lds
 s_waitcnt lgkmcnt(6)
 v_mfma_f32_32x32x16_bf16 v[96:111], v[40:43], v[36:39], v[96:111]
 v_mfma_f32_32x32x16_bf16 v[112:127], v[44:47], v[36:39], v[112:127]
 s_waitcnt vmcnt(7) lgkmcnt(0)
 s_barrier
 v_mfma_f32_32x32x16_bf16 v[64:79], v[56:59], v[48:51], v[64:79]
 ds_read_b128 v[32:35], v16 offset:0
 ds_read_b64_tr_b16 v[40:41], v5 offset:16384
 ds_read_b64_tr_b16 v[42:43], v5 offset:16896
 ds_read_b64_tr_b16 v[44:45], v5 offset:24576
 ds_read_b64_tr_b16 v[46:47], v5 offset:25088
 ds_read_b128 v[36:39], v16 offset:4096
 v_mfma_f32_32x32x16_bf16 v[80:95], v[60:63], v[48:51], v[80:95]
 s_add_u32 m0, s25, 33792
 s_mov_b32 s26, 640
 buffer_load_dwordx4 v3, s[44:47], s26 offen lds
 v_mfma_f32_32x32x16_bf16 v[96:111], v[56:59], v[52:55], v[96:111]
 s_add_u32 m0, s30, 65536
 s_mov_b32 s37, 1146880
 buffer_load_dwordx4 v4, s[48:51], s37 offen lds
 v_mfma_f32_32x32x16_bf16 v[112:127], v[60:63], v[52:55], v[112:127]
 s_waitcnt lgkmcnt(3)
 v_mfma_f32_32x32x16_bf16 v[64:79], v[40:43], v[32:35], v[64:79]
 ds_read_b128 v[48:51], v17 offset:0
 ds_read_b64_tr_b16 v[56:57], v5 offset:18432
 ds_read_b64_tr_b16 v[58:59], v5 offset:18944
 ds_read_b64_tr_b16 v[60:61], v5 offset:26624
 ds_read_b64_tr_b16 v[62:63], v5 offset:27136
 ds_read_b128 v[52:55], v17 offset:4096
 s_waitcnt lgkmcnt(7)
 v_mfma_f32_32x32x16_bf16 v[80:95], v[44:47], v[32:35], v[80:95]
 s_add_u32 m0, s30, 66560
 s_nop 0
 buffer_load_dwordx4 v8, s[48:51], s37 offen lds
 s_waitcnt lgkmcnt(6)
 v_mfma_f32_32x32x16_bf16 v[96:111], v[40:43], v[36:39], v[96:111]
 v_mfma_f32_32x32x16_bf16 v[112:127], v[44:47], v[36:39], v[112:127]
 s_waitcnt vmcnt(6) lgkmcnt(0)
 s_barrier
 v_mfma_f32_32x32x16_bf16 v[64:79], v[56:59], v[48:51], v[64:79]
 ds_read_b128 v[32:35], v14 offset:16384
 ds_read_b64_tr_b16 v[40:41], v5 offset:32768
 ds_read_b64_tr_b16 v[42:43], v5 offset:33280
 ds_read_b64_tr_b16 v[44:45], v5 offset:40960
 ds_read_b64_tr_b16 v[46:47], v5 offset:41472
 ds_read_b128 v[36:39], v14 offset:20480
 v_mfma_f32_32x32x16_bf16 v[80:95], v[60:63], v[48:51], v[80:95]
 s_add_u32 m0, s30, 81920
 s_mov_b32 s37, 1261568
 buffer_load_dwordx4 v4, s[48:51], s37 offen lds
 v_mfma_f32_32x32x16_bf16 v[96:111], v[56:59], v[52:55], v[96:111]
 s_add_u32 m0, s30, 82944
 s_nop 0
 buffer_load_dwordx4 v8, s[48:51], s37 offen lds
 v_mfma_f32_32x32x16_bf16 v[112:127], v[60:63], v[52:55], v[112:127]
 s_waitcnt lgkmcnt(3)
 v_mfma_f32_32x32x16_bf16 v[64:79], v[40:43], v[32:35], v[64:79]
 ds_read_b128 v[48:51], v15 offset:16384
 ds_read_b64_tr_b16 v[56:57], v5 offset:34816
 ds_read_b64_tr_b16 v[58:59], v5 offset:35328
 ds_read_b64_tr_b16 v[60:61], v5 offset:43008
 ds_read_b64_tr_b16 v[62:63], v5 offset:43520
 ds_read_b128 v[52:55], v15 offset:20480
 s_waitcnt lgkmcnt(7)
 v_mfma_f32_32x32x16_bf16 v[80:95], v[44:47], v[32:35], v[80:95]
 s_add_u32 m0, s25, 0
 s_mov_b32 s26, 768
 buffer_load_dwordx4 v2, s[44:47], s26 offen lds
 s_waitcnt lgkmcnt(6)
 v_mfma_f32_32x32x16_bf16 v[96:111], v[40:43], v[36:39], v[96:111]
 v_mfma_f32_32x32x16_bf16 v[112:127], v[44:47], v[36:39], v[112:127]
 s_waitcnt vmcnt(7) lgkmcnt(0)
 s_barrier
 v_mfma_f32_32x32x16_bf16 v[64:79], v[56:59], v[48:51], v[64:79]
 ds_read_b128 v[32:35], v16 offset:16384
 ds_read_b64_tr_b16 v[40:41], v6 offset:0
 ds_read_b64_tr_b16 v[42:43], v6 offset:512
 ds_read_b64_tr_b16 v[44:45], v6 offset:8192
 ds_read_b64_tr_b16 v[46:47], v6 offset:8704
 ds_read_b128 v[36:39], v16 offset:20480
 v_mfma_f32_32x32x16_bf16 v[80:95], v[60:63], v[48:51], v[80:95]
 s_add_u32 m0, s25, 1024
 s_mov_b32 s26, 768
 buffer_load_dwordx4 v3, s[44:47], s26 offen lds
 v_mfma_f32_32x32x16_bf16 v[96:111], v[56:59], v[52:55], v[96:111]
 s_add_u32 m0, s30, 0
 s_mov_b32 s37, 1376256
 buffer_load_dwordx4 v4, s[48:51], s37 offen lds
 v_mfma_f32_32x32x16_bf16 v[112:127], v[60:63], v[52:55], v[112:127]
 s_waitcnt lgkmcnt(3)
 v_mfma_f32_32x32x16_bf16 v[64:79], v[40:43], v[32:35], v[64:79]
 ds_read_b128 v[48:51], v17 offset:16384
 ds_read_b64_tr_b16 v[56:57], v6 offset:2048
 ds_read_b64_tr_b16 v[58:59], v6 offset:2560
 ds_read_b64_tr_b16 v[60:61], v6 offset:10240
 ds_read_b64_tr_b16 v[62:63], v6 offset:10752
 ds_read_b128 v[52:55], v17 offset:20480
 s_waitcnt lgkmcnt(7)
 v_mfma_f32_32x32x16_bf16 v[80:95], v[44:47], v[32:35], v[80:95]
 s_add_u32 m0, s30, 1024
 s_nop 0
 buffer_load_dwordx4 v8, s[48:51], s37 offen lds
 s_waitcnt lgkmcnt(6)
 v_mfma_f32_32x32x16_bf16 v[96:111], v[40:43], v[36:39], v[96:111]
 v_mfma_f32_32x32x16_bf16 v[112:127], v[44:47], v[36:39], v[112:127]
 s_waitcnt vmcnt(6) lgkmcnt(0)
 s_barrier
 v_mfma_f32_32x32x16_bf16 v[64:79], v[56:59], v[48:51], v[64:79]
 ds_read_b128 v[32:35], v14 offset:32768
 ds_read_b64_tr_b16 v[40:41], v6 offset:16384
 ds_read_b64_tr_b16 v[42:43], v6 offset:16896
 ds_read_b64_tr_b16 v[44:45], v6 offset:24576
 ds_read_b64_tr_b16 v[46:47], v6 offset:25088
 ds_read_b128 v[36:39], v14 offset:36864
 v_mfma_f32_32x32x16_bf16 v[80:95], v[60:63], v[48:51], v[80:95]
 s_add_u32 m0, s30, 16384
 s_mov_b32 s37, 1490944
 buffer_load_dwordx4 v4, s[48:51], s37 offen lds
 v_mfma_f32_32x32x16_bf16 v[96:111], v[56:59], v[52:55], v[96:111]
 s_add_u32 m0, s30, 17408
 s_nop 0
 buffer_load_dwordx4 v8, s[48:51], s37 offen lds
 v_mfma_f32_32x32x16_bf16 v[112:127], v[60:63], v[52:55], v[112:127]
 s_waitcnt lgkmcnt(3)
 v_mfma_f32_32x32x16_bf16 v[64:79], v[40:43], v[32:35], v[64:79]
 ds_read_b128 v[48:51], v15 offset:32768
 ds_read_b64_tr_b16 v[56:57], v6 offset:18432
 ds_read_b64_tr_b16 v[58:59], v6 offset:18944
 ds_read_b64_tr_b16 v[60:61], v6 offset:26624
 ds_read_b64_tr_b16 v[62:63], v6 offset:27136
 ds_read_b128 v[52:55], v15 offset:36864
 s_waitcnt lgkmcnt(7)
 v_mfma_f32_32x32x16_bf16 v[80:95], v[44:47], v[32:35], v[80:95]
 s_add_u32 m0, s25, 16384
 s_mov_b32 s26, 896
 buffer_load_dwordx4 v2, s[44:47], s26 offen lds
 s_waitcnt lgkmcnt(6)
 v_mfma_f32_32x32x16_bf16 v[96:111], v[40:43], v[36:39], v[96:111]
 v_mfma_f32_32x32x16_bf16 v[112:127], v[44:47], v[36:39], v[112:127]
 s_waitcnt vmcnt(7) lgkmcnt(0)
 s_barrier
 v_mfma_f32_32x32x16_bf16 v[64:79], v[56:59], v[48:51], v[64:79]
 ds_read_b128 v[32:35], v16 offset:32768
 ds_read_b64_tr_b16 v[40:41], v6 offset:32768
 ds_read_b64_tr_b16 v[42:43], v6 offset:33280
 ds_read_b64_tr_b16 v[44:45], v6 offset:40960
 ds_read_b64_tr_b16 v[46:47], v6 offset:41472
 ds_read_b128 v[36:39], v16 offset:36864
 v_mfma_f32_32x32x16_bf16 v[80:95], v[60:63], v[48:51], v[80:95]
 s_add_u32 m0, s25, 17408
 s_mov_b32 s26, 896
 buffer_load_dwordx4 v3, s[44:47], s26 offen lds
 v_mfma_f32_32x32x16_bf16 v[96:111], v[56:59], v[52:55], v[96:111]
 s_add_u32 m0, s30, 32768
 s_mov_b32 s37, 1605632
 buffer_load_dwordx4 v4, s[48:51], s37 offen lds
 v_mfma_f32_32x32x16_bf16 v[112:127], v[60:63], v[52:55], v[112:127]
 s_waitcnt lgkmcnt(3)
 v_mfma_f32_32x32x16_bf16 v[64:79], v[40:43], v[32:35], v[64:79]
 ds_read_b128 v[48:51], v17 offset:32768
 ds_read_b64_tr_b16 v[56:57], v6 offset:34816
 ds_read_b64_tr_b16 v[58:59], v6 offset:35328
 ds_read_b64_tr_b16 v[60:61], v6 offset:43008
 ds_read_b64_tr_b16 v[62:63], v6 offset:43520
 ds_read_b128 v[52:55], v17 offset:36864
 s_waitcnt lgkmcnt(7)
 v_mfma_f32_32x32x16_bf16 v[80:95], v[44:47], v[32:35], v[80:95]
 s_add_u32 m0, s30, 33792
 s_nop 0
 buffer_load_dwordx4 v8, s[48:51], s37 offen lds
 s_waitcnt lgkmcnt(6)
 v_mfma_f32_32x32x16_bf16 v[96:111], v[40:43], v[36:39], v[96:111]
 v_mfma_f32_32x32x16_bf16 v[112:127], v[44:47], v[36:39], v[112:127]
 s_waitcnt vmcnt(6) lgkmcnt(0)
 s_barrier
 v_mfma_f32_32x32x16_bf16 v[64:79], v[56:59], v[48:51], v[64:79]
 ds_read_b128 v[32:35], v14 offset:0
 ds_read_b64_tr_b16 v[40:41], v5 offset:0
 ds_read_b64_tr_b16 v[42:43], v5 offset:512
 ds_read_b64_tr_b16 v[44:45], v5 offset:8192
 ds_read_b64_tr_b16 v[46:47], v5 offset:8704
 ds_read_b128 v[36:39], v14 offset:4096
 v_mfma_f32_32x32x16_bf16 v[80:95], v[60:63], v[48:51], v[80:95]
 s_add_u32 m0, s30, 49152
 s_mov_b32 s37, 1720320
 buffer_load_dwordx4 v4, s[48:51], s37 offen lds
 v_mfma_f32_32x32x16_bf16 v[96:111], v[56:59], v[52:55], v[96:111]
 s_add_u32 m0, s30, 50176
 s_nop 0
 buffer_load_dwordx4 v8, s[48:51], s37 offen lds
 v_mfma_f32_32x32x16_bf16 v[112:127], v[60:63], v[52:55], v[112:127]
 s_waitcnt lgkmcnt(3)
 v_mfma_f32_32x32x16_bf16 v[64:79], v[40:43], v[32:35], v[64:79]
 ds_read_b128 v[48:51], v15 offset:0
 ds_read_b64_tr_b16 v[56:57], v5 offset:2048
 ds_read_b64_tr_b16 v[58:59], v5 offset:2560
 ds_read_b64_tr_b16 v[60:61], v5 offset:10240
 ds_read_b64_tr_b16 v[62:63], v5 offset:10752
 ds_read_b128 v[52:55], v15 offset:4096
 s_waitcnt lgkmcnt(7)
 v_mfma_f32_32x32x16_bf16 v[80:95], v[44:47], v[32:35], v[80:95]
 s_waitcnt lgkmcnt(6)
 v_mfma_f32_32x32x16_bf16 v[96:111], v[40:43], v[36:39], v[96:111]
 v_mfma_f32_32x32x16_bf16 v[112:127], v[44:47], v[36:39], v[112:127]
 s_waitcnt vmcnt(6) lgkmcnt(0)
 s_barrier
 v_mfma_f32_32x32x16_bf16 v[64:79], v[56:59], v[48:51], v[64:79]
 ds_read_b128 v[32:35], v16 offset:0
 ds_read_b64_tr_b16 v[40:41], v5 offset:16384
 ds_read_b64_tr_b16 v[42:43], v5 offset:16896
 ds_read_b64_tr_b16 v[44:45], v5 offset:24576
 ds_read_b64_tr_b16 v[46:47], v5 offset:25088
 ds_read_b128 v[36:39], v16 offset:4096
 v_mfma_f32_32x32x16_bf16 v[80:95], v[60:63], v[48:51], v[80:95]
 v_mfma_f32_32x32x16_bf16 v[96:111], v[56:59], v[52:55], v[96:111]
 v_mfma_f32_32x32x16_bf16 v[112:127], v[60:63], v[52:55], v[112:127]
 s_waitcnt lgkmcnt(3)
 v_mfma_f32_32x32x16_bf16 v[64:79], v[40:43], v[32:35], v[64:79]
 ds_read_b128 v[48:51], v17 offset:0
 ds_read_b64_tr_b16 v[56:57], v5 offset:18432
 ds_read_b64_tr_b16 v[58:59], v5 offset:18944
 ds_read_b64_tr_b16 v[60:61], v5 offset:26624
 ds_read_b64_tr_b16 v[62:63], v5 offset:27136
 ds_read_b128 v[52:55], v17 offset:4096
 s_waitcnt lgkmcnt(7)
 v_mfma_f32_32x32x16_bf16 v[80:95], v[44:47], v[32:35], v[80:95]
 s_waitcnt lgkmcnt(6)
 v_mfma_f32_32x32x16_bf16 v[96:111], v[40:43], v[36:39], v[96:111]
 v_mfma_f32_32x32x16_bf16 v[112:127], v[44:47], v[36:39], v[112:127]
 s_waitcnt vmcnt(2) lgkmcnt(0)
 s_barrier
 v_mfma_f32_32x32x16_bf16 v[64:79], v[56:59], v[48:51], v[64:79]
 ds_read_b128 v[32:35], v14 offset:16384
 ds_read_b64_tr_b16 v[40:41], v5 offset:32768
 ds_read_b64_tr_b16 v[42:43], v5 offset:33280
 ds_read_b64_tr_b16 v[44:45], v5 offset:40960
 ds_read_b64_tr_b16 v[46:47], v5 offset:41472
 ds_read_b128 v[36:39], v14 offset:20480
 v_mfma_f32_32x32x16_bf16 v[80:95], v[60:63], v[48:51], v[80:95]
 v_mfma_f32_32x32x16_bf16 v[96:111], v[56:59], v[52:55], v[96:111]
 v_mfma_f32_32x32x16_bf16 v[112:127], v[60:63], v[52:55], v[112:127]
 s_waitcnt lgkmcnt(3)
 v_mfma_f32_32x32x16_bf16 v[64:79], v[40:43], v[32:35], v[64:79]
 ds_read_b128 v[48:51], v15 offset:16384
 ds_read_b64_tr_b16 v[56:57], v5 offset:34816
 ds_read_b64_tr_b16 v[58:59], v5 offset:35328
 ds_read_b64_tr_b16 v[60:61], v5 offset:43008
 ds_read_b64_tr_b16 v[62:63], v5 offset:43520
 ds_read_b128 v[52:55], v15 offset:20480
 s_waitcnt lgkmcnt(7)
 v_mfma_f32_32x32x16_bf16 v[80:95], v[44:47], v[32:35], v[80:95]
 s_waitcnt lgkmcnt(6)
 v_mfma_f32_32x32x16_bf16 v[96:111], v[40:43], v[36:39], v[96:111]
 v_mfma_f32_32x32x16_bf16 v[112:127], v[44:47], v[36:39], v[112:127]
 s_waitcnt vmcnt(0) lgkmcnt(0)
 s_barrier
 v_mfma_f32_32x32x16_bf16 v[64:79], v[56:59], v[48:51], v[64:79]
 ds_read_b128 v[32:35], v16 offset:16384
 ds_read_b64_tr_b16 v[40:41], v6 offset:0
 ds_read_b64_tr_b16 v[42:43], v6 offset:512
 ds_read_b64_tr_b16 v[44:45], v6 offset:8192
 ds_read_b64_tr_b16 v[46:47], v6 offset:8704
 ds_read_b128 v[36:39], v16 offset:20480
 v_mfma_f32_32x32x16_bf16 v[80:95], v[60:63], v[48:51], v[80:95]
 v_mfma_f32_32x32x16_bf16 v[96:111], v[56:59], v[52:55], v[96:111]
 v_mfma_f32_32x32x16_bf16 v[112:127], v[60:63], v[52:55], v[112:127]
 s_waitcnt lgkmcnt(3)
 v_mfma_f32_32x32x16_bf16 v[64:79], v[40:43], v[32:35], v[64:79]
 ds_read_b128 v[48:51], v17 offset:16384
 ds_read_b64_tr_b16 v[56:57], v6 offset:2048
 ds_read_b64_tr_b16 v[58:59], v6 offset:2560
 ds_read_b64_tr_b16 v[60:61], v6 offset:10240
 ds_read_b64_tr_b16 v[62:63], v6 offset:10752
 ds_read_b128 v[52:55], v17 offset:20480
 s_waitcnt lgkmcnt(7)
 v_mfma_f32_32x32x16_bf16 v[80:95], v[44:47], v[32:35], v[80:95]
 s_waitcnt lgkmcnt(6)
 v_mfma_f32_32x32x16_bf16 v[96:111], v[40:43], v[36:39], v[96:111]
 v_mfma_f32_32x32x16_bf16 v[112:127], v[44:47], v[36:39], v[112:127]
 s_waitcnt lgkmcnt(0)
 s_barrier
 v_mfma_f32_32x32x16_bf16 v[64:79], v[56:59], v[48:51], v[64:79]
 s_lshl_b32 s3, s28, 7
 s_add_u32 s3, s3, 153600
 v_lshl_add_u32 v164, v23, 4, s3
 s_lshl_b32 s3, s27, 8
 s_add_u32 s3, s3, 149504
 v_lshl_add_u32 v165, v24, 2, s3
 ds_read_b32 v160, v165 offset:0
 ds_read_b32 v162, v165 offset:512
 ds_read_b32 v161, v165 offset:128
 ds_read_b32 v163, v165 offset:640
 ds_read_b128 v[128:131], v164 offset:0
 ds_read_b128 v[132:135], v164 offset:32
 ds_read_b128 v[136:139], v164 offset:64
 ds_read_b128 v[140:143], v164 offset:96
 ds_read_b128 v[144:147], v164 offset:512
 ds_read_b128 v[148:151], v164 offset:544
 ds_read_b128 v[152:155], v164 offset:576
 ds_read_b128 v[156:159], v164 offset:608
 v_mfma_f32_32x32x16_bf16 v[80:95], v[60:63], v[48:51], v[80:95]
 v_mfma_f32_32x32x16_bf16 v[96:111], v[56:59], v[52:55], v[96:111]
 v_mfma_f32_32x32x16_bf16 v[112:127], v[60:63], v[52:55], v[112:127]
K1_FEPI:
 s_waitcnt lgkmcnt(0)
 s_nop 7
 s_nop 7
 s_mov_b32 s41, 0xc0135761
 s_mov_b32 s42, 0xbdd2d3e8
 v_mul_f32 v35, v162, v162
 v_mul_f32 v32, s41, v162
 v_mul_f32 v33, s42, v162
 v_rcp_f32 v34, v35
 v_mul_f32 v33, v33, v35
 v_mul_f32 v39, v163, v163
 v_mul_f32 v36, s41, v163
 v_mul_f32 v37, s42, v163
 v_rcp_f32 v38, v39
 v_mul_f32 v37, v37, v39
 s_lshl_b32 s3, s23, 1
 s_add_u32 s3, s3, s27
 s_mul_i32 s3, s3, 112
 s_lshl_b32 s31, s24, 3
 s_add_u32 s3, s3, s31
 s_lshl_b32 s31, s28, 1
 s_add_u32 s3, s3, s31
 s_lshl_b32 s38, s3, 11
 v_pk_fma_f32 v[40:41], v[160:161], v[128:129], v[64:65] op_sel:[0,0,0] op_sel_hi:[0,1,1] neg_lo:[1,0,0] neg_hi:[1,0,0]
 v_pk_fma_f32 v[42:43], v[160:161], v[130:131], v[66:67] op_sel:[0,0,0] op_sel_hi:[0,1,1] neg_lo:[1,0,0] neg_hi:[1,0,0]
 v_pk_fma_f32 v[44:45], v[160:161], v[132:133], v[68:69] op_sel:[0,0,0] op_sel_hi:[0,1,1] neg_lo:[1,0,0] neg_hi:[1,0,0]
 v_pk_fma_f32 v[46:47], v[160:161], v[134:135], v[70:71] op_sel:[0,0,0] op_sel_hi:[0,1,1] neg_lo:[1,0,0] neg_hi:[1,0,0]
 v_pk_fma_f32 v[48:49], v[160:161], v[144:145], v[80:81] op_sel:[0,0,0] op_sel_hi:[0,1,1] neg_lo:[1,0,0] neg_hi:[1,0,0]
 v_pk_fma_f32 v[50:51], v[160:161], v[146:147], v[82:83] op_sel:[0,0,0] op_sel_hi:[0,1,1] neg_lo:[1,0,0] neg_hi:[1,0,0]
 v_pk_fma_f32 v[52:53], v[160:161], v[148:149], v[84:85] op_sel:[0,0,0] op_sel_hi:[0,1,1] neg_lo:[1,0,0] neg_hi:[1,0,0]
 v_pk_fma_f32 v[54:55], v[160:161], v[150:151], v[86:87] op_sel:[0,0,0] op_sel_hi:[0,1,1] neg_lo:[1,0,0] neg_hi:[1,0,0]
 v_pk_mul_f32 v[56:57], v[40:41], v[40:41]
 v_pk_mul_f32 v[58:59], v[42:43], v[42:43]
 v_pk_mul_f32 v[60:61], v[44:45], v[44:45]
 v_pk_mul_f32 v[62:63], v[46:47], v[46:47]
 v_pk_fma_f32 v[56:57], v[56:57], v[32:33], v[32:33] op_sel:[0,1,0] op_sel_hi:[1,1,0]
 v_pk_fma_f32 v[58:59], v[58:59], v[32:33], v[32:33] op_sel:[0,1,0] op_sel_hi:[1,1,0]
 v_pk_fma_f32 v[60:61], v[60:61], v[32:33], v[32:33] op_sel:[0,1,0] op_sel_hi:[1,1,0]
 v_pk_fma_f32 v[62:63], v[62:63], v[32:33], v[32:33] op_sel:[0,1,0] op_sel_hi:[1,1,0]
 v_pk_mul_f32 v[56:57], v[56:57], v[40:41]
 v_pk_mul_f32 v[58:59], v[58:59], v[42:43]
 v_pk_mul_f32 v[60:61], v[60:61], v[44:45]
 v_pk_mul_f32 v[62:63], v[62:63], v[46:47]
 v_exp_f32 v56, v56
 v_exp_f32 v57, v57
 v_exp_f32 v58, v58
 v_exp_f32 v59, v59
 v_exp_f32 v60, v60
 v_exp_f32 v61, v61
 v_exp_f32 v62, v62
 v_exp_f32 v63, v63
 v_pk_mul_f32 v[48:49], v[48:49], v[40:41]
 v_pk_mul_f32 v[50:51], v[50:51], v[42:43]
 v_pk_mul_f32 v[52:53], v[52:53], v[44:45]
 v_pk_mul_f32 v[54:55], v[54:55], v[46:47]
 v_pk_fma_f32 v[56:57], v[56:57], v[34:35], v[34:35] op_sel:[0,0,0] op_sel_hi:[1,0,0]
 v_pk_fma_f32 v[58:59], v[58:59], v[34:35], v[34:35] op_sel:[0,0,0] op_sel_hi:[1,0,0]
 v_pk_fma_f32 v[60:61], v[60:61], v[34:35], v[34:35] op_sel:[0,0,0] op_sel_hi:[1,0,0]
 v_pk_fma_f32 v[62:63], v[62:63], v[34:35], v[34:35] op_sel:[0,0,0] op_sel_hi:[1,0,0]
 v_rcp_f32 v56, v56
 v_rcp_f32 v57, v57
 v_rcp_f32 v58, v58
 v_rcp_f32 v59, v59
 v_rcp_f32 v60, v60
 v_rcp_f32 v61, v61
 v_rcp_f32 v62, v62
 v_rcp_f32 v63, v63
 v_pk_mul_f32 v[48:49], v[48:49], v[56:57]
 v_pk_mul_f32 v[50:51], v[50:51], v[58:59]
 v_pk_mul_f32 v[52:53], v[52:53], v[60:61]
 v_pk_mul_f32 v[54:55], v[54:55], v[62:63]
 v_cvt_pk_bf16_f32 v164, v48, v49
 v_cvt_pk_bf16_f32 v165, v50, v51
 v_cvt_pk_bf16_f32 v166, v52, v53
 v_cvt_pk_bf16_f32 v167, v54, v55
 buffer_store_dwordx4 v[164:167], v25, s[52:55], s38 offen offset:0 sc1
 v_pk_fma_f32 v[40:41], v[160:161], v[136:137], v[72:73] op_sel:[0,0,0] op_sel_hi:[0,1,1] neg_lo:[1,0,0] neg_hi:[1,0,0]
 v_pk_fma_f32 v[42:43], v[160:161], v[138:139], v[74:75] op_sel:[0,0,0] op_sel_hi:[0,1,1] neg_lo:[1,0,0] neg_hi:[1,0,0]
 v_pk_fma_f32 v[44:45], v[160:161], v[140:141], v[76:77] op_sel:[0,0,0] op_sel_hi:[0,1,1] neg_lo:[1,0,0] neg_hi:[1,0,0]
 v_pk_fma_f32 v[46:47], v[160:161], v[142:143], v[78:79] op_sel:[0,0,0] op_sel_hi:[0,1,1] neg_lo:[1,0,0] neg_hi:[1,0,0]
 v_pk_fma_f32 v[48:49], v[160:161], v[152:153], v[88:89] op_sel:[0,0,0] op_sel_hi:[0,1,1] neg_lo:[1,0,0] neg_hi:[1,0,0]
 v_pk_fma_f32 v[50:51], v[160:161], v[154:155], v[90:91] op_sel:[0,0,0] op_sel_hi:[0,1,1] neg_lo:[1,0,0] neg_hi:[1,0,0]
 v_pk_fma_f32 v[52:53], v[160:161], v[156:157], v[92:93] op_sel:[0,0,0] op_sel_hi:[0,1,1] neg_lo:[1,0,0] neg_hi:[1,0,0]
 v_pk_fma_f32 v[54:55], v[160:161], v[158:159], v[94:95] op_sel:[0,0,0] op_sel_hi:[0,1,1] neg_lo:[1,0,0] neg_hi:[1,0,0]
 v_pk_mul_f32 v[56:57], v[40:41], v[40:41]
 v_pk_mul_f32 v[58:59], v[42:43], v[42:43]
 v_pk_mul_f32 v[60:61], v[44:45], v[44:45]
 v_pk_mul_f32 v[62:63], v[46:47], v[46:47]
 v_pk_fma_f32 v[56:57], v[56:57], v[32:33], v[32:33] op_sel:[0,1,0] op_sel_hi:[1,1,0]
 v_pk_fma_f32 v[58:59], v[58:59], v[32:33], v[32:33] op_sel:[0,1,0] op_sel_hi:[1,1,0]
 v_pk_fma_f32 v[60:61], v[60:61], v[32:33], v[32:33] op_sel:[0,1,0] op_sel_hi:[1,1,0]
 v_pk_fma_f32 v[62:63], v[62:63], v[32:33], v[32:33] op_sel:[0,1,0] op_sel_hi:[1,1,0]
 v_pk_mul_f32 v[56:57], v[56:57], v[40:41]
 v_pk_mul_f32 v[58:59], v[58:59], v[42:43]
 v_pk_mul_f32 v[60:61], v[60:61], v[44:45]
 v_pk_mul_f32 v[62:63], v[62:63], v[46:47]
 v_exp_f32 v56, v56
 v_exp_f32 v57, v57
 v_exp_f32 v58, v58
 v_exp_f32 v59, v59
 v_exp_f32 v60, v60
 v_exp_f32 v61, v61
 v_exp_f32 v62, v62
 v_exp_f32 v63, v63
 v_pk_mul_f32 v[48:49], v[48:49], v[40:41]
 v_pk_mul_f32 v[50:51], v[50:51], v[42:43]
 v_pk_mul_f32 v[52:53], v[52:53], v[44:45]
 v_pk_mul_f32 v[54:55], v[54:55], v[46:47]
 v_pk_fma_f32 v[56:57], v[56:57], v[34:35], v[34:35] op_sel:[0,0,0] op_sel_hi:[1,0,0]
 v_pk_fma_f32 v[58:59], v[58:59], v[34:35], v[34:35] op_sel:[0,0,0] op_sel_hi:[1,0,0]
 v_pk_fma_f32 v[60:61], v[60:61], v[34:35], v[34:35] op_sel:[0,0,0] op_sel_hi:[1,0,0]
 v_pk_fma_f32 v[62:63], v[62:63], v[34:35], v[34:35] op_sel:[0,0,0] op_sel_hi:[1,0,0]
 v_rcp_f32 v56, v56
 v_rcp_f32 v57, v57
 v_rcp_f32 v58, v58
 v_rcp_f32 v59, v59
 v_rcp_f32 v60, v60
 v_rcp_f32 v61, v61
 v_rcp_f32 v62, v62
 v_rcp_f32 v63, v63
 v_pk_mul_f32 v[48:49], v[48:49], v[56:57]
 v_pk_mul_f32 v[50:51], v[50:51], v[58:59]
 v_pk_mul_f32 v[52:53], v[52:53], v[60:61]
 v_pk_mul_f32 v[54:55], v[54:55], v[62:63]
 v_cvt_pk_bf16_f32 v168, v48, v49
 v_cvt_pk_bf16_f32 v169, v50, v51
 v_cvt_pk_bf16_f32 v170, v52, v53
 v_cvt_pk_bf16_f32 v171, v54, v55
 buffer_store_dwordx4 v[168:171], v25, s[52:55], s38 offen offset:2048 sc1
 v_pk_fma_f32 v[40:41], v[160:161], v[128:129], v[96:97] op_sel:[1,0,0] op_sel_hi:[1,1,1] neg_lo:[1,0,0] neg_hi:[1,0,0]
 v_pk_fma_f32 v[42:43], v[160:161], v[130:131], v[98:99] op_sel:[1,0,0] op_sel_hi:[1,1,1] neg_lo:[1,0,0] neg_hi:[1,0,0]
 v_pk_fma_f32 v[44:45], v[160:161], v[132:133], v[100:101] op_sel:[1,0,0] op_sel_hi:[1,1,1] neg_lo:[1,0,0] neg_hi:[1,0,0]
 v_pk_fma_f32 v[46:47], v[160:161], v[134:135], v[102:103] op_sel:[1,0,0] op_sel_hi:[1,1,1] neg_lo:[1,0,0] neg_hi:[1,0,0]
 v_pk_fma_f32 v[48:49], v[160:161], v[144:145], v[112:113] op_sel:[1,0,0] op_sel_hi:[1,1,1] neg_lo:[1,0,0] neg_hi:[1,0,0]
 v_pk_fma_f32 v[50:51], v[160:161], v[146:147], v[114:115] op_sel:[1,0,0] op_sel_hi:[1,1,1] neg_lo:[1,0,0] neg_hi:[1,0,0]
 v_pk_fma_f32 v[52:53], v[160:161], v[148:149], v[116:117] op_sel:[1,0,0] op_sel_hi:[1,1,1] neg_lo:[1,0,0] neg_hi:[1,0,0]
 v_pk_fma_f32 v[54:55], v[160:161], v[150:151], v[118:119] op_sel:[1,0,0] op_sel_hi:[1,1,1] neg_lo:[1,0,0] neg_hi:[1,0,0]
 v_pk_mul_f32 v[56:57], v[40:41], v[40:41]
 v_pk_mul_f32 v[58:59], v[42:43], v[42:43]
 v_pk_mul_f32 v[60:61], v[44:45], v[44:45]
 v_pk_mul_f32 v[62:63], v[46:47], v[46:47]
 v_pk_fma_f32 v[56:57], v[56:57], v[36:37], v[36:37] op_sel:[0,1,0] op_sel_hi:[1,1,0]
 v_pk_fma_f32 v[58:59], v[58:59], v[36:37], v[36:37] op_sel:[0,1,0] op_sel_hi:[1,1,0]
 v_pk_fma_f32 v[60:61], v[60:61], v[36:37], v[36:37] op_sel:[0,1,0] op_sel_hi:[1,1,0]
 v_pk_fma_f32 v[62:63], v[62:63], v[36:37], v[36:37] op_sel:[0,1,0] op_sel_hi:[1,1,0]
 v_pk_mul_f32 v[56:57], v[56:57], v[40:41]
 v_pk_mul_f32 v[58:59], v[58:59], v[42:43]
 v_pk_mul_f32 v[60:61], v[60:61], v[44:45]
 v_pk_mul_f32 v[62:63], v[62:63], v[46:47]
 v_exp_f32 v56, v56
 v_exp_f32 v57, v57
 v_exp_f32 v58, v58
 v_exp_f32 v59, v59
 v_exp_f32 v60, v60
 v_exp_f32 v61, v61
 v_exp_f32 v62, v62
 v_exp_f32 v63, v63
 v_pk_mul_f32 v[48:49], v[48:49], v[40:41]
 v_pk_mul_f32 v[50:51], v[50:51], v[42:43]
 v_pk_mul_f32 v[52:53], v[52:53], v[44:45]
 v_pk_mul_f32 v[54:55], v[54:55], v[46:47]
 v_pk_fma_f32 v[56:57], v[56:57], v[38:39], v[38:39] op_sel:[0,0,0] op_sel_hi:[1,0,0]
 v_pk_fma_f32 v[58:59], v[58:59], v[38:39], v[38:39] op_sel:[0,0,0] op_sel_hi:[1,0,0]
 v_pk_fma_f32 v[60:61], v[60:61], v[38:39], v[38:39] op_sel:[0,0,0] op_sel_hi:[1,0,0]
 v_pk_fma_f32 v[62:63], v[62:63], v[38:39], v[38:39] op_sel:[0,0,0] op_sel_hi:[1,0,0]
 v_rcp_f32 v56, v56
 v_rcp_f32 v57, v57
 v_rcp_f32 v58, v58
 v_rcp_f32 v59, v59
 v_rcp_f32 v60, v60
 v_rcp_f32 v61, v61
 v_rcp_f32 v62, v62
 v_rcp_f32 v63, v63
 v_pk_mul_f32 v[48:49], v[48:49], v[56:57]
 v_pk_mul_f32 v[50:51], v[50:51], v[58:59]
 v_pk_mul_f32 v[52:53], v[52:53], v[60:61]
 v_pk_mul_f32 v[54:55], v[54:55], v[62:63]
 v_cvt_pk_bf16_f32 v164, v48, v49
 v_cvt_pk_bf16_f32 v165, v50, v51
 v_cvt_pk_bf16_f32 v166, v52, v53
 v_cvt_pk_bf16_f32 v167, v54, v55
 buffer_store_dwordx4 v[164:167], v25, s[52:55], s38 offen offset:1024 sc1
 v_pk_fma_f32 v[40:41], v[160:161], v[136:137], v[104:105] op_sel:[1,0,0] op_sel_hi:[1,1,1] neg_lo:[1,0,0] neg_hi:[1,0,0]
 v_pk_fma_f32 v[42:43], v[160:161], v[138:139], v[106:107] op_sel:[1,0,0] op_sel_hi:[1,1,1] neg_lo:[1,0,0] neg_hi:[1,0,0]
 v_pk_fma_f32 v[44:45], v[160:161], v[140:141], v[108:109] op_sel:[1,0,0] op_sel_hi:[1,1,1] neg_lo:[1,0,0] neg_hi:[1,0,0]
 v_pk_fma_f32 v[46:47], v[160:161], v[142:143], v[110:111] op_sel:[1,0,0] op_sel_hi:[1,1,1] neg_lo:[1,0,0] neg_hi:[1,0,0]
 v_pk_fma_f32 v[48:49], v[160:161], v[152:153], v[120:121] op_sel:[1,0,0] op_sel_hi:[1,1,1] neg_lo:[1,0,0] neg_hi:[1,0,0]
 v_pk_fma_f32 v[50:51], v[160:161], v[154:155], v[122:123] op_sel:[1,0,0] op_sel_hi:[1,1,1] neg_lo:[1,0,0] neg_hi:[1,0,0]
 v_pk_fma_f32 v[52:53], v[160:161], v[156:157], v[124:125] op_sel:[1,0,0] op_sel_hi:[1,1,1] neg_lo:[1,0,0] neg_hi:[1,0,0]
 v_pk_fma_f32 v[54:55], v[160:161], v[158:159], v[126:127] op_sel:[1,0,0] op_sel_hi:[1,1,1] neg_lo:[1,0,0] neg_hi:[1,0,0]
 v_pk_mul_f32 v[56:57], v[40:41], v[40:41]
 v_pk_mul_f32 v[58:59], v[42:43], v[42:43]
 v_pk_mul_f32 v[60:61], v[44:45], v[44:45]
 v_pk_mul_f32 v[62:63], v[46:47], v[46:47]
 v_pk_fma_f32 v[56:57], v[56:57], v[36:37], v[36:37] op_sel:[0,1,0] op_sel_hi:[1,1,0]
 v_pk_fma_f32 v[58:59], v[58:59], v[36:37], v[36:37] op_sel:[0,1,0] op_sel_hi:[1,1,0]
 v_pk_fma_f32 v[60:61], v[60:61], v[36:37], v[36:37] op_sel:[0,1,0] op_sel_hi:[1,1,0]
 v_pk_fma_f32 v[62:63], v[62:63], v[36:37], v[36:37] op_sel:[0,1,0] op_sel_hi:[1,1,0]
 v_pk_mul_f32 v[56:57], v[56:57], v[40:41]
 v_pk_mul_f32 v[58:59], v[58:59], v[42:43]
 v_pk_mul_f32 v[60:61], v[60:61], v[44:45]
 v_pk_mul_f32 v[62:63], v[62:63], v[46:47]
 v_exp_f32 v56, v56
 v_exp_f32 v57, v57
 v_exp_f32 v58, v58
 v_exp_f32 v59, v59
 v_exp_f32 v60, v60
 v_exp_f32 v61, v61
 v_exp_f32 v62, v62
 v_exp_f32 v63, v63
 v_pk_mul_f32 v[48:49], v[48:49], v[40:41]
 v_pk_mul_f32 v[50:51], v[50:51], v[42:43]
 v_pk_mul_f32 v[52:53], v[52:53], v[44:45]
 v_pk_mul_f32 v[54:55], v[54:55], v[46:47]
 v_pk_fma_f32 v[56:57], v[56:57], v[38:39], v[38:39] op_sel:[0,0,0] op_sel_hi:[1,0,0]
 v_pk_fma_f32 v[58:59], v[58:59], v[38:39], v[38:39] op_sel:[0,0,0] op_sel_hi:[1,0,0]
 v_pk_fma_f32 v[60:61], v[60:61], v[38:39], v[38:39] op_sel:[0,0,0] op_sel_hi:[1,0,0]
 v_pk_fma_f32 v[62:63], v[62:63], v[38:39], v[38:39] op_sel:[0,0,0] op_sel_hi:[1,0,0]
 v_rcp_f32 v56, v56
 v_rcp_f32 v57, v57
 v_rcp_f32 v58, v58
 v_rcp_f32 v59, v59
 v_rcp_f32 v60, v60
 v_rcp_f32 v61, v61
 v_rcp_f32 v62, v62
 v_rcp_f32 v63, v63
 v_pk_mul_f32 v[48:49], v[48:49], v[56:57]
 v_pk_mul_f32 v[50:51], v[50:51], v[58:59]
 v_pk_mul_f32 v[52:53], v[52:53], v[60:61]
 v_pk_mul_f32 v[54:55], v[54:55], v[62:63]
 v_cvt_pk_bf16_f32 v168, v48, v49
 v_cvt_pk_bf16_f32 v169, v50, v51
 v_cvt_pk_bf16_f32 v170, v52, v53
 v_cvt_pk_bf16_f32 v171, v54, v55
 buffer_store_dwordx4 v[168:171], v25, s[52:55], s38 offen offset:3072 sc1
 s_endpgm
K1_FB:
 s_nop 4
 s_lshl_b32 s3, s23, 6
 s_and_b32 s31, s28, 1
 s_lshl_b32 s31, s31, 4
 s_add_u32 s3, s3, s31
 v_add_u32 v31, s3, v26
 s_bitcmp1_b32 s28, 1
 s_cselect_b32 s3, -1, 0
 v_xor_b32 v31, s3, v31
 v_xor_b32 v8, v27, v22
 v_lshlrev_b32 v8, 4, v8
 s_cselect_b32 s3, 2017, 32
 v_add_u32 v2, s3, v31
 v_lshl_add_u32 v2, v2, 10, v8
 s_cselect_b32 s3, 2009, 40
 v_add_u32 v3, s3, v31
 v_lshl_add_u32 v3, v3, 10, v8
 v_xor_b32 v3, 64, v3
 s_lshr_b32 s31, s28, 1
 s_lshl_b32 s31, s31, 7
 s_add_u32 s3, s83, s31
 s_and_b32 s31, s28, 1
 s_mul_i32 s31, s31, 57344
 s_add_u32 s3, s3, s31
 v_mul_u32_u24 v4, 3584, v26
 v_and_b32 v8, 1, v22
 v_lshlrev_b32 v8, 2, v8
 v_xor_b32 v8, v8, v27
 v_lshlrev_b32 v8, 4, v8
 v_add3_u32 v4, v4, v8, s3
 v_add_u32 v8, 28672, v4
 s_lshl_b32 s25, s28, 11
 s_add_u32 s30, s25, 49152
 s_mov_b32 s50, 1835008
 s_mov_b32 s51, 0x20000
 s_waitcnt lgkmcnt(0)
 s_mov_b32 s44, s4
 s_mov_b32 s45, s5
 s_mov_b32 s48, s14
 s_mov_b32 s49, s15
 s_add_u32 m0, s25, 8192
 s_mov_b32 s26, 0
 buffer_load_dwordx4 v2, s[44:47], s26 offen lds
 s_add_u32 m0, s25, 9216
 s_mov_b32 s26, 0
 buffer_load_dwordx4 v3, s[44:47], s26 offen lds
 s_add_u32 m0, s30, 8192
 s_mov_b32 s37, 0
 buffer_load_dwordx4 v4, s[48:51], s37 offen lds
 s_add_u32 m0, s30, 9216
 s_nop 0
 buffer_load_dwordx4 v8, s[48:51], s37 offen lds
 v_lshrrev_b32 v23, 5, v1
 v_and_b32 v24, 31, v1
 v_lshrrev_b32 v14, 1, v24
 v_and_b32 v14, 7, v14
 v_xor_b32 v14, v14, v23
 v_lshlrev_b32 v14, 4, v14
 v_lshlrev_b32 v15, 7, v24
 s_lshl_b32 s3, s27, 13
 v_add3_u32 v14, v14, v15, s3
 v_xor_b32 v15, 32, v14
 v_xor_b32 v16, 64, v14
 v_xor_b32 v17, 0x60, v14
 v_and_b32 v29, 3, v21
 v_and_b32 v5, 1, v22
 v_lshlrev_b32 v5, 5, v5
 v_lshl_add_u32 v6, v20, 3, v5
 v_lshlrev_b32 v5, 7, v29
 v_lshl_add_u32 v5, v23, 10, v5
 v_lshl_add_u32 v29, v29, 6, v6
 v_add_u32 v5, v5, v6
 v_and_b32 v6, 1, v26
 s_and_b32 s3, s28, 1
 v_xor_b32 v6, s3, v6
 v_lshlrev_b32 v6, 6, v6
 s_lshr_b32 s3, s28, 1
 s_lshl_b32 s3, s3, 12
 s_add_u32 s3, s3, 49152
 v_add3_u32 v5, v5, v6, s3
 v_add_u32 v6, 49152, v5
 s_lshr_b32 s3, s23, 2
 s_lshl_b32 s3, s3, 2
 s_add_u32 s3, s3, s28
 s_mul_i32 s76, s3, 114688
 s_and_b32 s3, s23, 1
 s_lshl_b32 s3, s3, 7
 s_add_u32 s76, s76, s3
 s_add_u32 s76, s76, s83
 v_mul_u32_u24 v30, 3584, v26
 v_lshlrev_b32 v31, 1, v22
 v_xor_b32 v31, v31, v27
 v_lshl_add_u32 v30, v31, 4, v30
 s_bitcmp1_b32 s23, 1
 s_cselect_b32 s64, s14, s12
 s_cselect_b32 s65, s15, s13
 s_mov_b32 s66, 1835008
 s_mov_b32 s67, 0x20000
 s_lshl_b32 s29, s28, 12
 s_add_u32 s29, s29, 147456
 s_add_u32 m0, s29, 0
 s_nop 0
 buffer_load_dwordx4 v30, s[64:67], s76 offen lds
 s_add_u32 s76, s76, 28672
 s_add_u32 m0, s29, 1024
 s_nop 0
 buffer_load_dwordx4 v30, s[64:67], s76 offen lds
 s_add_u32 s76, s76, 28672
 s_add_u32 m0, s29, 2048
 s_nop 0
 buffer_load_dwordx4 v30, s[64:67], s76 offen lds
 s_add_u32 s76, s76, 28672
 s_add_u32 m0, s29, 3072
 s_nop 0
 buffer_load_dwordx4 v30, s[64:67], s76 offen lds
 s_add_u32 s76, s76, 28672
 s_add_u32 m0, s30, 24576
 s_mov_b32 s37, 114688
 buffer_load_dwordx4 v4, s[48:51], s37 offen lds
 s_add_u32 m0, s30, 25600
 s_nop 0
 buffer_load_dwordx4 v8, s[48:51], s37 offen lds
 s_add_u32 m0, s25, 24576
 s_mov_b32 s26, 128
 buffer_load_dwordx4 v2, s[44:47], s26 offen lds
 s_add_u32 m0, s25, 25600
 s_mov_b32 s26, 128
 buffer_load_dwordx4 v3, s[44:47], s26 offen lds
 s_mov_b32 s18, s74
 s_mov_b32 s19, s75
 s_mov_b32 s52, s18
 s_mov_b32 s53, s19
 s_mov_b32 s54, 7340032
 s_mov_b32 s55, 0x20000
 s_add_u32 s68, s18, 15728640
 s_addc_u32 s69, s19, 0
 s_mov_b32 s70, 196608
 s_mov_b32 s71, 0x20000
 s_mov_b32 s74, 256
 s_mov_b32 s75, 0x20000
 v_lshlrev_b32 v10, 2, v1
 s_lshl_b32 s78, s24, 12
 s_add_u32 s78, s78, 131072
 s_and_b32 s3, s23, 3
 s_lshl_b32 s3, s3, 2
 s_add_u32 s3, s3, s28
 s_lshl_b32 s3, s3, 8
 s_lshr_b32 s79, s23, 2
 s_lshl_b32 s79, s79, 2
 s_add_u32 s79, s79, s3
 s_add_u32 s79, s79, s78
 v_mov_b32 v31, 0x1000000
 v_cmp_gt_u32 vcc, 16, v1
 s_nop 1
 v_cndmask_b32 v9, v31, v25, vcc
 v_cmp_eq_u32 vcc, 0x100, v0
 s_and_b32 s3, s2, 63
 s_lshl_b32 s3, s3, 2
 v_mov_b32 v11, s3
 v_cndmask_b32 v11, v31, v11, vcc
 v_mov_b32 v176, 1
 v_and_b32 v18, 3, v26
 v_xor_b32 v18, s28, v18
 v_lshlrev_b32 v18, 5, v18
 v_lshl_add_u32 v18, v21, 7, v18
 v_lshl_add_u32 v18, v20, 3, v18
 v_add_u32 v18, 147456, v18
 s_lshl_b32 s3, s28, 10
 v_add_u32 v13, s3, v25
 s_lshl_b32 s3, s28, 8
 s_add_u32 s3, s3, 153600
 v_add_u32 v169, s3, v10
 v_lshrrev_b32 v7, 1, v1
 s_lshl_b32 s3, s28, 5
 v_add_u32 v7, s3, v7
 v_and_b32 v31, 1, v1
 v_lshlrev_b32 v168, 10, v31
 v_lshl_add_u32 v168, v7, 2, v168
 v_add_u32 v168, 149504, v168
 v_mov_b32 v179, 157696
 v_mov_b32 v172, 0x3f803f80
 v_mov_b32 v173, 0x3f803f80
 v_mov_b32 v174, 0x3f803f80
 v_mov_b32 v175, 0x3f803f80
 s_lshl_b32 s3, s23, 6
 s_lshr_b32 s31, s28, 1
 s_lshl_b32 s31, s31, 5
 s_add_u32 s3, s3, s31
 v_lshrrev_b32 v7, 1, v1
 v_add_u32 v7, s3, v7
 s_bitcmp1_b32 s28, 0
 s_cselect_b32 s3, -1, 0
 s_cselect_b32 s31, 0x801, 0
 v_xor_b32 v7, s3, v7
 v_add_u32 v7, s31, v7
 v_mov_b32 v19, 0x400
 v_cmp_eq_u32 vcc, 0x800, v7
 s_nop 1
 v_cndmask_b32 v7, v7, v19, vcc
 v_lshlrev_b32 v7, 4, v7
 v_lshl_add_u32 v7, v31, 3, v7
 s_mul_i32 s32, s23, 14
 s_add_u32 s32, s32, s24
 s_lshr_b32 s33, s32, 1
 s_and_b32 s32, s32, 1
 s_lshl_b32 s32, s32, 2
 s_add_u32 s32, s32, s28
 s_lshl_b32 s34, s33, 14
 s_lshl_b32 s3, s32, 7
 s_add_u32 s34, s34, s3
 s_add_u32 s36, s34, 64
 v_lshlrev_b32 v28, 10, v21
 v_lshl_add_u32 v28, v20, 4, v28
 s_mul_i32 s3, s32, 112
 s_add_u32 s3, s3, s33
 s_lshl_b32 s35, s3, 11
 v_lshlrev_b32 v31, 8, v23
 v_add3_u32 v29, v29, v31, s29
 s_mov_b32 s56, s16
 s_mov_b32 s57, s17
 s_mov_b32 s58, 1835008
 s_mov_b32 s59, 0x20000
 s_add_u32 s60, s18, 8388608
 s_addc_u32 s61, s19, 0
 s_mov_b32 s62, 1835008
 s_mov_b32 s63, 0x20000
 s_waitcnt vmcnt(8)
 s_barrier
 ds_read_b128 v[32:35], v14 offset:0
 ds_read_b64_tr_b16 v[40:41], v5 offset:0
 ds_read_b64_tr_b16 v[42:43], v5 offset:512
 ds_read_b64_tr_b16 v[44:45], v5 offset:8192
 ds_read_b64_tr_b16 v[46:47], v5 offset:8704
 ds_read_b128 v[36:39], v14 offset:4096
 ds_read_b128 v[48:51], v15 offset:0
 ds_read_b64_tr_b16 v[56:57], v5 offset:2048
 ds_read_b64_tr_b16 v[58:59], v5 offset:2560
 ds_read_b64_tr_b16 v[60:61], v5 offset:10240
 ds_read_b64_tr_b16 v[62:63], v5 offset:10752
 ds_read_b128 v[52:55], v15 offset:4096
 s_waitcnt lgkmcnt(9)
 v_mfma_f32_32x32x16_bf16 v[64:79], v[40:43], v[32:35], 0
 s_add_u32 m0, s30, 40960
 s_mov_b32 s37, 229376
 buffer_load_dwordx4 v4, s[48:51], s37 offen lds
 s_waitcnt lgkmcnt(7)
 v_mfma_f32_32x32x16_bf16 v[80:95], v[44:47], v[32:35], 0
 s_add_u32 m0, s30, 41984
 s_nop 0
 buffer_load_dwordx4 v8, s[48:51], s37 offen lds
 s_waitcnt lgkmcnt(6)
 v_mfma_f32_32x32x16_bf16 v[96:111], v[40:43], v[36:39], 0
 v_mfma_f32_32x32x16_bf16 v[112:127], v[44:47], v[36:39], 0
 s_waitcnt vmcnt(4) lgkmcnt(0)
 s_barrier
 ds_read_b128 v[32:35], v16 offset:0
 ds_read_b64_tr_b16 v[40:41], v5 offset:16384
 ds_read_b64_tr_b16 v[42:43], v5 offset:16896
 ds_read_b64_tr_b16 v[44:45], v5 offset:24576
 ds_read_b64_tr_b16 v[46:47], v5 offset:25088
 ds_read_b128 v[36:39], v16 offset:4096
 v_mfma_f32_32x32x16_bf16 v[64:79], v[56:59], v[48:51], v[64:79]
 s_add_u32 m0, s30, 57344
 s_mov_b32 s37, 344064
 buffer_load_dwordx4 v4, s[48:51], s37 offen lds
 v_mfma_f32_32x32x16_bf16 v[80:95], v[60:63], v[48:51], v[80:95]
 s_add_u32 m0, s30, 58368
 s_nop 0
 buffer_load_dwordx4 v8, s[48:51], s37 offen lds
 v_mfma_f32_32x32x16_bf16 v[96:111], v[56:59], v[52:55], v[96:111]
 v_mfma_f32_32x32x16_bf16 v[112:127], v[60:63], v[52:55], v[112:127]
 ds_read_b128 v[48:51], v17 offset:0
 ds_read_b64_tr_b16 v[56:57], v5 offset:18432
 ds_read_b64_tr_b16 v[58:59], v5 offset:18944
 ds_read_b64_tr_b16 v[60:61], v5 offset:26624
 ds_read_b64_tr_b16 v[62:63], v5 offset:27136
 ds_read_b128 v[52:55], v17 offset:4096
 ds_read_b64_tr_b16 v[136:137], v18 offset:0
 ds_read_b64_tr_b16 v[138:139], v18 offset:2048
 ds_read_b64_tr_b16 v[140:141], v18 offset:4096
 ds_read_b64_tr_b16 v[142:143], v18 offset:6144
 ds_read_b64_tr_b16 v[144:145], v18 offset:8192
 ds_read_b64_tr_b16 v[146:147], v18 offset:10240
 ds_read_b64_tr_b16 v[148:149], v18 offset:12288
 ds_read_b64_tr_b16 v[150:151], v18 offset:14336
 s_waitcnt lgkmcnt(15)
 v_mfma_f32_32x32x16_bf16 v[64:79], v[40:43], v[32:35], v[64:79]
 s_add_u32 m0, s25, 40960
 s_mov_b32 s26, 256
 buffer_load_dwordx4 v2, s[44:47], s26 offen lds
 v_mfma_f32_32x32x16_bf16 v[80:95], v[44:47], v[32:35], v[80:95]
 s_add_u32 m0, s25, 41984
 s_mov_b32 s26, 256
 buffer_load_dwordx4 v3, s[44:47], s26 offen lds
 s_waitcnt lgkmcnt(14)
 v_mfma_f32_32x32x16_bf16 v[96:111], v[40:43], v[36:39], v[96:111]
 v_mfma_f32_32x32x16_bf16 v[112:127], v[44:47], v[36:39], v[112:127]
 s_waitcnt vmcnt(4) lgkmcnt(0)
 s_barrier
 ds_read_b128 v[32:35], v14 offset:16384
 ds_read_b64_tr_b16 v[40:41], v5 offset:32768
 ds_read_b64_tr_b16 v[42:43], v5 offset:33280
 ds_read_b64_tr_b16 v[44:45], v5 offset:40960
 ds_read_b64_tr_b16 v[46:47], v5 offset:41472
 ds_read_b128 v[36:39], v14 offset:20480
 v_mfma_f32_32x32x16_bf16 v[64:79], v[56:59], v[48:51], v[64:79]
 s_add_u32 m0, s30, 73728
 s_mov_b32 s37, 458752
 buffer_load_dwordx4 v4, s[48:51], s37 offen lds
 v_mfma_f32_16x16x32_bf16 v[152:155], v[172:175], v[136:139], 0
 v_mfma_f32_32x32x16_bf16 v[80:95], v[60:63], v[48:51], v[80:95]
 s_add_u32 m0, s30, 74752
 s_nop 0
 buffer_load_dwordx4 v8, s[48:51], s37 offen lds
 v_mfma_f32_16x16x32_bf16 v[152:155], v[172:175], v[140:143], v[152:155]
 v_mfma_f32_32x32x16_bf16 v[96:111], v[56:59], v[52:55], v[96:111]
 v_mfma_f32_16x16x32_bf16 v[152:155], v[172:175], v[144:147], v[152:155]
 v_mfma_f32_32x32x16_bf16 v[112:127], v[60:63], v[52:55], v[112:127]
 v_mfma_f32_16x16x32_bf16 v[152:155], v[172:175], v[148:151], v[152:155]
 s_nop 7
 buffer_store_dword v152, v9, s[68:71], s79 offen sc1
 ds_read_b128 v[48:51], v15 offset:16384
 ds_read_b64_tr_b16 v[56:57], v5 offset:34816
 ds_read_b64_tr_b16 v[58:59], v5 offset:35328
 ds_read_b64_tr_b16 v[60:61], v5 offset:43008
 ds_read_b64_tr_b16 v[62:63], v5 offset:43520
 ds_read_b128 v[52:55], v15 offset:20480
 s_waitcnt lgkmcnt(9)
 v_mfma_f32_32x32x16_bf16 v[64:79], v[40:43], v[32:35], v[64:79]
 s_add_u32 m0, s30, 90112
 s_mov_b32 s37, 573440
 buffer_load_dwordx4 v4, s[48:51], s37 offen lds
 s_waitcnt lgkmcnt(7)
 v_mfma_f32_32x32x16_bf16 v[80:95], v[44:47], v[32:35], v[80:95]
 s_add_u32 m0, s30, 91136
 s_nop 0
 buffer_load_dwordx4 v8, s[48:51], s37 offen lds
 s_waitcnt lgkmcnt(6)
 v_mfma_f32_32x32x16_bf16 v[96:111], v[40:43], v[36:39], v[96:111]
 v_mfma_f32_32x32x16_bf16 v[112:127], v[44:47], v[36:39], v[112:127]
 s_waitcnt vmcnt(7) lgkmcnt(0)
 s_barrier
 ds_read_b128 v[32:35], v16 offset:16384
 ds_read_b64_tr_b16 v[40:41], v6 offset:0
 ds_read_b64_tr_b16 v[42:43], v6 offset:512
 ds_read_b64_tr_b16 v[44:45], v6 offset:8192
 ds_read_b64_tr_b16 v[46:47], v6 offset:8704
 ds_read_b128 v[36:39], v16 offset:20480
 v_mfma_f32_32x32x16_bf16 v[64:79], v[56:59], v[48:51], v[64:79]
 s_add_u32 m0, s25, 8192
 s_mov_b32 s26, 384
 buffer_load_dwordx4 v2, s[44:47], s26 offen lds
 v_mfma_f32_32x32x16_bf16 v[80:95], v[60:63], v[48:51], v[80:95]
 s_add_u32 m0, s25, 9216
 s_mov_b32 s26, 384
 buffer_load_dwordx4 v3, s[44:47], s26 offen lds
 v_mfma_f32_32x32x16_bf16 v[96:111], v[56:59], v[52:55], v[96:111]
 v_mfma_f32_32x32x16_bf16 v[112:127], v[60:63], v[52:55], v[112:127]
 ds_read_b128 v[48:51], v17 offset:16384
 ds_read_b64_tr_b16 v[56:57], v6 offset:2048
 ds_read_b64_tr_b16 v[58:59], v6 offset:2560
 ds_read_b64_tr_b16 v[60:61], v6 offset:10240
 ds_read_b64_tr_b16 v[62:63], v6 offset:10752
 ds_read_b128 v[52:55], v17 offset:20480
 s_waitcnt lgkmcnt(9)
 v_mfma_f32_32x32x16_bf16 v[64:79], v[40:43], v[32:35], v[64:79]
 s_add_u32 m0, s30, 8192
 s_mov_b32 s37, 688128
 buffer_load_dwordx4 v4, s[48:51], s37 offen lds
 s_waitcnt lgkmcnt(7)
 v_mfma_f32_32x32x16_bf16 v[80:95], v[44:47], v[32:35], v[80:95]
 s_add_u32 m0, s30, 9216
 s_nop 0
 buffer_load_dwordx4 v8, s[48:51], s37 offen lds
 s_waitcnt lgkmcnt(6)
 v_mfma_f32_32x32x16_bf16 v[96:111], v[40:43], v[36:39], v[96:111]
 v_mfma_f32_32x32x16_bf16 v[112:127], v[44:47], v[36:39], v[112:127]
 s_waitcnt vmcnt(7) lgkmcnt(0)
 s_barrier
 ds_read_b128 v[32:35], v14 offset:32768
 ds_read_b64_tr_b16 v[40:41], v6 offset:16384
 ds_read_b64_tr_b16 v[42:43], v6 offset:16896
 ds_read_b64_tr_b16 v[44:45], v6 offset:24576
 ds_read_b64_tr_b16 v[46:47], v6 offset:25088
 ds_read_b128 v[36:39], v14 offset:36864
 v_mfma_f32_32x32x16_bf16 v[64:79], v[56:59], v[48:51], v[64:79]
 s_add_u32 m0, s30, 24576
 s_mov_b32 s37, 802816
 buffer_load_dwordx4 v4, s[48:51], s37 offen lds
 v_mfma_f32_32x32x16_bf16 v[80:95], v[60:63], v[48:51], v[80:95]
 v_mfma_f32_32x32x16_bf16 v[96:111], v[56:59], v[52:55], v[96:111]
 v_mfma_f32_32x32x16_bf16 v[112:127], v[60:63], v[52:55], v[112:127]
 ds_read_b128 v[48:51], v15 offset:32768
 ds_read_b64_tr_b16 v[56:57], v6 offset:18432
 ds_read_b64_tr_b16 v[58:59], v6 offset:18944
 ds_read_b64_tr_b16 v[60:61], v6 offset:26624
 ds_read_b64_tr_b16 v[62:63], v6 offset:27136
 ds_read_b128 v[52:55], v15 offset:36864
 s_waitcnt lgkmcnt(9)
 v_mfma_f32_32x32x16_bf16 v[64:79], v[40:43], v[32:35], v[64:79]
 s_add_u32 m0, s30, 25600
 s_nop 0
 buffer_load_dwordx4 v8, s[48:51], s37 offen lds
 s_waitcnt lgkmcnt(7)
 v_mfma_f32_32x32x16_bf16 v[80:95], v[44:47], v[32:35], v[80:95]
 s_add_u32 m0, s25, 24576
 s_mov_b32 s26, 512
 buffer_load_dwordx4 v2, s[44:47], s26 offen lds
 s_waitcnt lgkmcnt(6)
 v_mfma_f32_32x32x16_bf16 v[96:111], v[40:43], v[36:39], v[96:111]
 v_mfma_f32_32x32x16_bf16 v[112:127], v[44:47], v[36:39], v[112:127]
 s_waitcnt vmcnt(7) lgkmcnt(0)
 s_barrier
 ds_read_b128 v[32:35], v16 offset:32768
 ds_read_b64_tr_b16 v[40:41], v6 offset:32768
 ds_read_b64_tr_b16 v[42:43], v6 offset:33280
 ds_read_b64_tr_b16 v[44:45], v6 offset:40960
 ds_read_b64_tr_b16 v[46:47], v6 offset:41472
 ds_read_b128 v[36:39], v16 offset:36864
 buffer_atomic_add v176, v11, s[72:75], 0 offen sc1
 s_mov_b32 m0, s29
 s_nop 0
 buffer_load_dwordx4 v28, s[56:59], s34 offen lds
 s_add_u32 m0, s29, 1024
 s_nop 0
 buffer_load_dwordx4 v28, s[56:59], s36 offen lds
 v_mfma_f32_32x32x16_bf16 v[64:79], v[56:59], v[48:51], v[64:79]
 s_add_u32 m0, s25, 25600
 s_mov_b32 s26, 512
 buffer_load_dwordx4 v3, s[44:47], s26 offen lds
 v_mfma_f32_32x32x16_bf16 v[80:95], v[60:63], v[48:51], v[80:95]
 v_mfma_f32_32x32x16_bf16 v[96:111], v[56:59], v[52:55], v[96:111]
 v_mfma_f32_32x32x16_bf16 v[112:127], v[60:63], v[52:55], v[112:127]
 ds_read_b128 v[48:51], v17 offset:32768
 ds_read_b64_tr_b16 v[56:57], v6 offset:34816
 ds_read_b64_tr_b16 v[58:59], v6 offset:35328
 ds_read_b64_tr_b16 v[60:61], v6 offset:43008
 ds_read_b64_tr_b16 v[62:63], v6 offset:43520
 ds_read_b128 v[52:55], v17 offset:36864
 s_waitcnt lgkmcnt(9)
 v_mfma_f32_32x32x16_bf16 v[64:79], v[40:43], v[32:35], v[64:79]
 s_add_u32 m0, s30, 40960
 s_mov_b32 s37, 917504
 buffer_load_dwordx4 v4, s[48:51], s37 offen lds
 s_waitcnt lgkmcnt(7)
 v_mfma_f32_32x32x16_bf16 v[80:95], v[44:47], v[32:35], v[80:95]
 s_add_u32 m0, s30, 41984
 s_nop 0
 buffer_load_dwordx4 v8, s[48:51], s37 offen lds
 s_waitcnt lgkmcnt(6)
 v_mfma_f32_32x32x16_bf16 v[96:111], v[40:43], v[36:39], v[96:111]
 v_mfma_f32_32x32x16_bf16 v[112:127], v[44:47], v[36:39], v[112:127]
 s_waitcnt vmcnt(9) lgkmcnt(0)
 s_barrier
 ds_read_b128 v[32:35], v14 offset:0
 ds_read_b64_tr_b16 v[40:41], v5 offset:0
 ds_read_b64_tr_b16 v[42:43], v5 offset:512
 ds_read_b64_tr_b16 v[44:45], v5 offset:8192
 ds_read_b64_tr_b16 v[46:47], v5 offset:8704
 ds_read_b128 v[36:39], v14 offset:4096
 v_mfma_f32_32x32x16_bf16 v[64:79], v[56:59], v[48:51], v[64:79]
 s_add_u32 m0, s30, 57344
 s_mov_b32 s37, 1032192
 buffer_load_dwordx4 v4, s[48:51], s37 offen lds
 v_mfma_f32_32x32x16_bf16 v[80:95], v[60:63], v[48:51], v[80:95]
 v_mfma_f32_32x32x16_bf16 v[96:111], v[56:59], v[52:55], v[96:111]
 v_mfma_f32_32x32x16_bf16 v[112:127], v[60:63], v[52:55], v[112:127]
 ds_read_b128 v[48:51], v15 offset:0
 ds_read_b64_tr_b16 v[56:57], v5 offset:2048
 ds_read_b64_tr_b16 v[58:59], v5 offset:2560
 ds_read_b64_tr_b16 v[60:61], v5 offset:10240
 ds_read_b64_tr_b16 v[62:63], v5 offset:10752
 ds_read_b128 v[52:55], v15 offset:4096
 s_waitcnt lgkmcnt(9)
 v_mfma_f32_32x32x16_bf16 v[64:79], v[40:43], v[32:35], v[64:79]
 s_add_u32 m0, s30, 58368
 s_nop 0
 buffer_load_dwordx4 v8, s[48:51], s37 offen lds
 s_waitcnt lgkmcnt(7)
 v_mfma_f32_32x32x16_bf16 v[80:95], v[44:47], v[32:35], v[80:95]
 s_add_u32 m0, s25, 40960
 s_mov_b32 s26, 640
 buffer_load_dwordx4 v2, s[44:47], s26 offen lds
 s_waitcnt lgkmcnt(6)
 v_mfma_f32_32x32x16_bf16 v[96:111], v[40:43], v[36:39], v[96:111]
 v_mfma_f32_32x32x16_bf16 v[112:127], v[44:47], v[36:39], v[112:127]
 s_waitcnt vmcnt(10) lgkmcnt(0)
 s_barrier
 ds_read_b128 v[32:35], v16 offset:0
 ds_read_b64_tr_b16 v[40:41], v5 offset:16384
 ds_read_b64_tr_b16 v[42:43], v5 offset:16896
 ds_read_b64_tr_b16 v[44:45], v5 offset:24576
 ds_read_b64_tr_b16 v[46:47], v5 offset:25088
 ds_read_b128 v[36:39], v16 offset:4096
 v_mfma_f32_32x32x16_bf16 v[64:79], v[56:59], v[48:51], v[64:79]
 s_add_u32 m0, s25, 41984
 s_mov_b32 s26, 640
 buffer_load_dwordx4 v3, s[44:47], s26 offen lds
 v_mfma_f32_32x32x16_bf16 v[80:95], v[60:63], v[48:51], v[80:95]
 v_mfma_f32_32x32x16_bf16 v[96:111], v[56:59], v[52:55], v[96:111]
 v_mfma_f32_32x32x16_bf16 v[112:127], v[60:63], v[52:55], v[112:127]
 ds_read_b128 v[48:51], v17 offset:0
 ds_read_b64_tr_b16 v[56:57], v5 offset:18432
 ds_read_b64_tr_b16 v[58:59], v5 offset:18944
 ds_read_b64_tr_b16 v[60:61], v5 offset:26624
 ds_read_b64_tr_b16 v[62:63], v5 offset:27136
 ds_read_b128 v[52:55], v17 offset:4096
 s_waitcnt lgkmcnt(9)
 v_mfma_f32_32x32x16_bf16 v[64:79], v[40:43], v[32:35], v[64:79]
 s_add_u32 m0, s30, 73728
 s_mov_b32 s37, 1146880
 buffer_load_dwordx4 v4, s[48:51], s37 offen lds
 s_waitcnt lgkmcnt(7)
 v_mfma_f32_32x32x16_bf16 v[80:95], v[44:47], v[32:35], v[80:95]
 s_add_u32 m0, s30, 74752
 s_nop 0
 buffer_load_dwordx4 v8, s[48:51], s37 offen lds
 s_waitcnt lgkmcnt(6)
 v_mfma_f32_32x32x16_bf16 v[96:111], v[40:43], v[36:39], v[96:111]
 v_mfma_f32_32x32x16_bf16 v[112:127], v[44:47], v[36:39], v[112:127]
 s_waitcnt vmcnt(6) lgkmcnt(0)
 s_barrier
 ds_read_b128 v[32:35], v14 offset:16384
 ds_read_b64_tr_b16 v[40:41], v5 offset:32768
 ds_read_b64_tr_b16 v[42:43], v5 offset:33280
 ds_read_b64_tr_b16 v[44:45], v5 offset:40960
 ds_read_b64_tr_b16 v[46:47], v5 offset:41472
 ds_read_b128 v[36:39], v14 offset:20480
 v_mfma_f32_32x32x16_bf16 v[64:79], v[56:59], v[48:51], v[64:79]
 s_add_u32 m0, s30, 90112
 s_mov_b32 s37, 1261568
 buffer_load_dwordx4 v4, s[48:51], s37 offen lds
 v_mfma_f32_32x32x16_bf16 v[80:95], v[60:63], v[48:51], v[80:95]
 v_mfma_f32_32x32x16_bf16 v[96:111], v[56:59], v[52:55], v[96:111]
 v_mfma_f32_32x32x16_bf16 v[112:127], v[60:63], v[52:55], v[112:127]
 ds_read_b128 v[48:51], v15 offset:16384
 ds_read_b64_tr_b16 v[56:57], v5 offset:34816
 ds_read_b64_tr_b16 v[58:59], v5 offset:35328
 ds_read_b64_tr_b16 v[60:61], v5 offset:43008
 ds_read_b64_tr_b16 v[62:63], v5 offset:43520
 ds_read_b128 v[52:55], v15 offset:20480
 ds_read_b64_tr_b16 v[192:193], v29 offset:0
 ds_read_b64_tr_b16 v[194:195], v29 offset:512
 ds_read_b64_tr_b16 v[196:197], v29 offset:1024
 ds_read_b64_tr_b16 v[198:199], v29 offset:1536
 s_waitcnt lgkmcnt(13)
 v_mfma_f32_32x32x16_bf16 v[64:79], v[40:43], v[32:35], v[64:79]
 s_add_u32 m0, s30, 91136
 s_nop 0
 buffer_load_dwordx4 v8, s[48:51], s37 offen lds
 s_waitcnt lgkmcnt(11)
 v_mfma_f32_32x32x16_bf16 v[80:95], v[44:47], v[32:35], v[80:95]
 s_add_u32 m0, s25, 8192
 s_mov_b32 s26, 768
 buffer_load_dwordx4 v2, s[44:47], s26 offen lds
 s_waitcnt lgkmcnt(10)
 v_mfma_f32_32x32x16_bf16 v[96:111], v[40:43], v[36:39], v[96:111]
 v_mfma_f32_32x32x16_bf16 v[112:127], v[44:47], v[36:39], v[112:127]
 s_waitcnt vmcnt(7) lgkmcnt(0)
 s_barrier
 ds_read_b128 v[32:35], v16 offset:16384
 ds_read_b64_tr_b16 v[40:41], v6 offset:0
 ds_read_b64_tr_b16 v[42:43], v6 offset:512
 ds_read_b64_tr_b16 v[44:45], v6 offset:8192
 ds_read_b64_tr_b16 v[46:47], v6 offset:8704
 ds_read_b128 v[36:39], v16 offset:20480
 buffer_store_dwordx4 v[192:195], v25, s[60:63], s35 offen sc1
 buffer_store_dwordx4 v[196:199], v25, s[60:63], s35 offen offset:1024 sc1
 v_mfma_f32_32x32x16_bf16 v[64:79], v[56:59], v[48:51], v[64:79]
 s_add_u32 m0, s25, 9216
 s_mov_b32 s26, 768
 buffer_load_dwordx4 v3, s[44:47], s26 offen lds
 v_mfma_f32_32x32x16_bf16 v[80:95], v[60:63], v[48:51], v[80:95]
 v_mfma_f32_32x32x16_bf16 v[96:111], v[56:59], v[52:55], v[96:111]
 v_mfma_f32_32x32x16_bf16 v[112:127], v[60:63], v[52:55], v[112:127]
 ds_read_b128 v[48:51], v17 offset:16384
 ds_read_b64_tr_b16 v[56:57], v6 offset:2048
 ds_read_b64_tr_b16 v[58:59], v6 offset:2560
 ds_read_b64_tr_b16 v[60:61], v6 offset:10240
 ds_read_b64_tr_b16 v[62:63], v6 offset:10752
 ds_read_b128 v[52:55], v17 offset:20480
 s_waitcnt lgkmcnt(9)
 v_mfma_f32_32x32x16_bf16 v[64:79], v[40:43], v[32:35], v[64:79]
 s_add_u32 m0, s30, 8192
 s_mov_b32 s37, 1376256
 buffer_load_dwordx4 v4, s[48:51], s37 offen lds
 s_waitcnt lgkmcnt(7)
 v_mfma_f32_32x32x16_bf16 v[80:95], v[44:47], v[32:35], v[80:95]
 s_add_u32 m0, s30, 9216
 s_nop 0
 buffer_load_dwordx4 v8, s[48:51], s37 offen lds
 s_waitcnt lgkmcnt(6)
 v_mfma_f32_32x32x16_bf16 v[96:111], v[40:43], v[36:39], v[96:111]
 v_mfma_f32_32x32x16_bf16 v[112:127], v[44:47], v[36:39], v[112:127]
 s_waitcnt vmcnt(8) lgkmcnt(0)
 s_barrier
 ds_read_b128 v[32:35], v14 offset:32768
 ds_read_b64_tr_b16 v[40:41], v6 offset:16384
 ds_read_b64_tr_b16 v[42:43], v6 offset:16896
 ds_read_b64_tr_b16 v[44:45], v6 offset:24576
 ds_read_b64_tr_b16 v[46:47], v6 offset:25088
 ds_read_b128 v[36:39], v14 offset:36864
 v_mfma_f32_32x32x16_bf16 v[64:79], v[56:59], v[48:51], v[64:79]
 s_add_u32 m0, s30, 24576
 s_mov_b32 s37, 1490944
 buffer_load_dwordx4 v4, s[48:51], s37 offen lds
 v_mfma_f32_32x32x16_bf16 v[80:95], v[60:63], v[48:51], v[80:95]
 v_mfma_f32_32x32x16_bf16 v[96:111], v[56:59], v[52:55], v[96:111]
 v_mfma_f32_32x32x16_bf16 v[112:127], v[60:63], v[52:55], v[112:127]
 ds_read_b128 v[48:51], v15 offset:32768
 ds_read_b64_tr_b16 v[56:57], v6 offset:18432
 ds_read_b64_tr_b16 v[58:59], v6 offset:18944
 ds_read_b64_tr_b16 v[60:61], v6 offset:26624
 ds_read_b64_tr_b16 v[62:63], v6 offset:27136
 ds_read_b128 v[52:55], v15 offset:36864
 s_waitcnt lgkmcnt(9)
 v_mfma_f32_32x32x16_bf16 v[64:79], v[40:43], v[32:35], v[64:79]
 s_add_u32 m0, s30, 25600
 s_nop 0
 buffer_load_dwordx4 v8, s[48:51], s37 offen lds
 s_waitcnt lgkmcnt(7)
 v_mfma_f32_32x32x16_bf16 v[80:95], v[44:47], v[32:35], v[80:95]
 s_add_u32 m0, s25, 24576
 s_mov_b32 s26, 896
 buffer_load_dwordx4 v2, s[44:47], s26 offen lds
 s_waitcnt lgkmcnt(6)
 v_mfma_f32_32x32x16_bf16 v[96:111], v[40:43], v[36:39], v[96:111]
 v_mfma_f32_32x32x16_bf16 v[112:127], v[44:47], v[36:39], v[112:127]
 s_waitcnt vmcnt(9) lgkmcnt(0)
 s_barrier
 ds_read_b128 v[32:35], v16 offset:32768
 ds_read_b64_tr_b16 v[40:41], v6 offset:32768
 ds_read_b64_tr_b16 v[42:43], v6 offset:33280
 ds_read_b64_tr_b16 v[44:45], v6 offset:40960
 ds_read_b64_tr_b16 v[46:47], v6 offset:41472
 ds_read_b128 v[36:39], v16 offset:36864
 s_cmp_lg_u32 s20, 4
 s_cbranch_scc1 K1_NLFB
 buffer_load_dword v177, v10, s[72:75], 0 offen sc1
K1_NLFB:
 v_mfma_f32_32x32x16_bf16 v[64:79], v[56:59], v[48:51], v[64:79]
 s_add_u32 m0, s25, 25600
 s_mov_b32 s26, 896
 buffer_load_dwordx4 v3, s[44:47], s26 offen lds
 v_mfma_f32_32x32x16_bf16 v[80:95], v[60:63], v[48:51], v[80:95]
 v_mfma_f32_32x32x16_bf16 v[96:111], v[56:59], v[52:55], v[96:111]
 v_mfma_f32_32x32x16_bf16 v[112:127], v[60:63], v[52:55], v[112:127]
 ds_read_b128 v[48:51], v17 offset:32768
 ds_read_b64_tr_b16 v[56:57], v6 offset:34816
 ds_read_b64_tr_b16 v[58:59], v6 offset:35328
 ds_read_b64_tr_b16 v[60:61], v6 offset:43008
 ds_read_b64_tr_b16 v[62:63], v6 offset:43520
 ds_read_b128 v[52:55], v17 offset:36864
 s_waitcnt lgkmcnt(9)
 v_mfma_f32_32x32x16_bf16 v[64:79], v[40:43], v[32:35], v[64:79]
 s_add_u32 m0, s30, 40960
 s_mov_b32 s37, 1605632
 buffer_load_dwordx4 v4, s[48:51], s37 offen lds
 s_waitcnt lgkmcnt(7)
 v_mfma_f32_32x32x16_bf16 v[80:95], v[44:47], v[32:35], v[80:95]
 s_add_u32 m0, s30, 41984
 s_nop 0
 buffer_load_dwordx4 v8, s[48:51], s37 offen lds
 s_waitcnt lgkmcnt(6)
 v_mfma_f32_32x32x16_bf16 v[96:111], v[40:43], v[36:39], v[96:111]
 v_mfma_f32_32x32x16_bf16 v[112:127], v[44:47], v[36:39], v[112:127]
 s_waitcnt vmcnt(6) lgkmcnt(0)
 s_barrier
 ds_read_b128 v[32:35], v14 offset:0
 ds_read_b64_tr_b16 v[40:41], v5 offset:0
 ds_read_b64_tr_b16 v[42:43], v5 offset:512
 ds_read_b64_tr_b16 v[44:45], v5 offset:8192
 ds_read_b64_tr_b16 v[46:47], v5 offset:8704
 ds_read_b128 v[36:39], v14 offset:4096
 v_mfma_f32_32x32x16_bf16 v[64:79], v[56:59], v[48:51], v[64:79]
 s_add_u32 m0, s30, 57344
 s_mov_b32 s37, 1720320
 buffer_load_dwordx4 v4, s[48:51], s37 offen lds
 v_mfma_f32_32x32x16_bf16 v[80:95], v[60:63], v[48:51], v[80:95]
 v_mfma_f32_32x32x16_bf16 v[96:111], v[56:59], v[52:55], v[96:111]
 v_mfma_f32_32x32x16_bf16 v[112:127], v[60:63], v[52:55], v[112:127]
 ds_read_b128 v[48:51], v15 offset:0
 ds_read_b64_tr_b16 v[56:57], v5 offset:2048
 ds_read_b64_tr_b16 v[58:59], v5 offset:2560
 ds_read_b64_tr_b16 v[60:61], v5 offset:10240
 ds_read_b64_tr_b16 v[62:63], v5 offset:10752
 ds_read_b128 v[52:55], v15 offset:4096
 s_waitcnt lgkmcnt(9)
 v_mfma_f32_32x32x16_bf16 v[64:79], v[40:43], v[32:35], v[64:79]
 s_add_u32 m0, s30, 58368
 s_nop 0
 buffer_load_dwordx4 v8, s[48:51], s37 offen lds
 s_waitcnt lgkmcnt(7)
 v_mfma_f32_32x32x16_bf16 v[80:95], v[44:47], v[32:35], v[80:95]
 s_waitcnt lgkmcnt(6)
 v_mfma_f32_32x32x16_bf16 v[96:111], v[40:43], v[36:39], v[96:111]
 v_mfma_f32_32x32x16_bf16 v[112:127], v[44:47], v[36:39], v[112:127]
 s_cmp_lg_u32 s20, 4
 s_cbranch_scc1 K1_NPFB
 s_mov_b32 s85, 0
K1_PLFB:
 s_waitcnt vmcnt(0)
 v_cmp_ne_u32 vcc, 4, v177
 v_mov_b32 v180, 0
 s_cbranch_vccz K1_PWFB
 v_mov_b32 v180, 1
 s_add_u32 s85, s85, 1
 s_cmp_ge_u32 s85, 200
 s_cbranch_scc1 K1_PWFB
 s_sleep 8
 buffer_load_dword v177, v10, s[72:75], 0 offen sc1
 s_branch K1_PLFB
K1_PWFB:
 ds_write_b32 v179, v180
 s_waitcnt lgkmcnt(0)
K1_NPFB:
 s_waitcnt vmcnt(6) lgkmcnt(0)
 s_barrier
 ds_read_b32 v177, v179
 s_mov_b32 s3, 65536
 buffer_load_dwordx2 v[164:165], v7, s[68:71], s3 offen sc1
 buffer_load_dwordx4 v[128:131], v13, s[68:71], s78 offen sc1
 ds_read_b128 v[32:35], v16 offset:0
 ds_read_b64_tr_b16 v[40:41], v5 offset:16384
 ds_read_b64_tr_b16 v[42:43], v5 offset:16896
 ds_read_b64_tr_b16 v[44:45], v5 offset:24576
 ds_read_b64_tr_b16 v[46:47], v5 offset:25088
 ds_read_b128 v[36:39], v16 offset:4096
 v_mfma_f32_32x32x16_bf16 v[64:79], v[56:59], v[48:51], v[64:79]
 v_mfma_f32_32x32x16_bf16 v[80:95], v[60:63], v[48:51], v[80:95]
 v_mfma_f32_32x32x16_bf16 v[96:111], v[56:59], v[52:55], v[96:111]
 v_mfma_f32_32x32x16_bf16 v[112:127], v[60:63], v[52:55], v[112:127]
 ds_read_b128 v[48:51], v17 offset:0
 ds_read_b64_tr_b16 v[56:57], v5 offset:18432
 ds_read_b64_tr_b16 v[58:59], v5 offset:18944
 ds_read_b64_tr_b16 v[60:61], v5 offset:26624
 ds_read_b64_tr_b16 v[62:63], v5 offset:27136
 ds_read_b128 v[52:55], v17 offset:4096
 s_waitcnt lgkmcnt(9)
 v_mfma_f32_32x32x16_bf16 v[64:79], v[40:43], v[32:35], v[64:79]
 s_waitcnt lgkmcnt(7)
 v_mfma_f32_32x32x16_bf16 v[80:95], v[44:47], v[32:35], v[80:95]
 s_waitcnt lgkmcnt(6)
 v_mfma_f32_32x32x16_bf16 v[96:111], v[40:43], v[36:39], v[96:111]
 v_mfma_f32_32x32x16_bf16 v[112:127], v[44:47], v[36:39], v[112:127]
 s_waitcnt vmcnt(4) lgkmcnt(0)
 s_barrier
 ds_read_b128 v[32:35], v14 offset:16384
 ds_read_b64_tr_b16 v[40:41], v5 offset:32768
 ds_read_b64_tr_b16 v[42:43], v5 offset:33280
 ds_read_b64_tr_b16 v[44:45], v5 offset:40960
 ds_read_b64_tr_b16 v[46:47], v5 offset:41472
 ds_read_b128 v[36:39], v14 offset:20480
 v_mfma_f32_32x32x16_bf16 v[64:79], v[56:59], v[48:51], v[64:79]
 v_mfma_f32_32x32x16_bf16 v[80:95], v[60:63], v[48:51], v[80:95]
 v_mfma_f32_32x32x16_bf16 v[96:111], v[56:59], v[52:55], v[96:111]
 v_mfma_f32_32x32x16_bf16 v[112:127], v[60:63], v[52:55], v[112:127]
 ds_read_b128 v[48:51], v15 offset:16384
 ds_read_b64_tr_b16 v[56:57], v5 offset:34816
 ds_read_b64_tr_b16 v[58:59], v5 offset:35328
 ds_read_b64_tr_b16 v[60:61], v5 offset:43008
 ds_read_b64_tr_b16 v[62:63], v5 offset:43520
 ds_read_b128 v[52:55], v15 offset:20480
 s_waitcnt lgkmcnt(9)
 v_mfma_f32_32x32x16_bf16 v[64:79], v[40:43], v[32:35], v[64:79]
 s_waitcnt lgkmcnt(7)
 v_mfma_f32_32x32x16_bf16 v[80:95], v[44:47], v[32:35], v[80:95]
 s_waitcnt lgkmcnt(6)
 v_mfma_f32_32x32x16_bf16 v[96:111], v[40:43], v[36:39], v[96:111]
 v_mfma_f32_32x32x16_bf16 v[112:127], v[44:47], v[36:39], v[112:127]
 s_waitcnt vmcnt(2) lgkmcnt(0)
 s_barrier
 ds_read_b128 v[32:35], v16 offset:16384
 ds_read_b64_tr_b16 v[40:41], v6 offset:0
 ds_read_b64_tr_b16 v[42:43], v6 offset:512
 ds_read_b64_tr_b16 v[44:45], v6 offset:8192
 ds_read_b64_tr_b16 v[46:47], v6 offset:8704
 ds_read_b128 v[36:39], v16 offset:20480
 v_mfma_f32_32x32x16_bf16 v[64:79], v[56:59], v[48:51], v[64:79]
 v_mfma_f32_32x32x16_bf16 v[80:95], v[60:63], v[48:51], v[80:95]
 v_mfma_f32_32x32x16_bf16 v[96:111], v[56:59], v[52:55], v[96:111]
 v_mfma_f32_32x32x16_bf16 v[112:127], v[60:63], v[52:55], v[112:127]
 ds_read_b128 v[48:51], v17 offset:16384
 ds_read_b64_tr_b16 v[56:57], v6 offset:2048
 ds_read_b64_tr_b16 v[58:59], v6 offset:2560
 ds_read_b64_tr_b16 v[60:61], v6 offset:10240
 ds_read_b64_tr_b16 v[62:63], v6 offset:10752
 ds_read_b128 v[52:55], v17 offset:20480
 s_waitcnt lgkmcnt(9)
 v_mfma_f32_32x32x16_bf16 v[64:79], v[40:43], v[32:35], v[64:79]
 s_waitcnt lgkmcnt(7)
 v_mfma_f32_32x32x16_bf16 v[80:95], v[44:47], v[32:35], v[80:95]
 s_waitcnt lgkmcnt(6)
 v_mfma_f32_32x32x16_bf16 v[96:111], v[40:43], v[36:39], v[96:111]
 v_mfma_f32_32x32x16_bf16 v[112:127], v[44:47], v[36:39], v[112:127]
 v_cmp_ne_u32 vcc, 0, v177
 s_cbranch_vccnz K1_SLOWFB
 s_waitcnt vmcnt(0)
 v_add_f32 v128, v128, v129
 v_add_f32 v130, v130, v131
 ds_write2_b32 v168, v164, v165 offset1:128
 v_add_f32 v128, v128, v130
 ds_write_b32 v169, v128
K1_BACKFB:
 s_waitcnt lgkmcnt(0)
 s_barrier
 s_lshl_b32 s3, s28, 7
 s_add_u32 s3, s3, 153600
 v_lshl_add_u32 v164, v23, 4, s3
 s_lshl_b32 s3, s27, 8
 s_add_u32 s3, s3, 149504
 v_lshl_add_u32 v165, v24, 2, s3
 ds_read_b32 v160, v165 offset:0
 ds_read_b32 v162, v165 offset:512
 ds_read_b32 v161, v165 offset:128
 ds_read_b32 v163, v165 offset:640
 ds_read_b128 v[128:131], v164 offset:0
 ds_read_b128 v[132:135], v164 offset:32
 ds_read_b128 v[136:139], v164 offset:64
 ds_read_b128 v[140:143], v164 offset:96
 ds_read_b128 v[144:147], v164 offset:512
 ds_read_b128 v[148:151], v164 offset:544
 ds_read_b128 v[152:155], v164 offset:576
 ds_read_b128 v[156:159], v164 offset:608
 v_mfma_f32_32x32x16_bf16 v[64:79], v[56:59], v[48:51], v[64:79]
 v_mfma_f32_32x32x16_bf16 v[80:95], v[60:63], v[48:51], v[80:95]
 v_mfma_f32_32x32x16_bf16 v[96:111], v[56:59], v[52:55], v[96:111]
 v_mfma_f32_32x32x16_bf16 v[112:127], v[60:63], v[52:55], v[112:127]
 s_branch K1_FEPI
K1_SLOWFB:
 s_waitcnt vmcnt(0)
 v_lshlrev_b32 v168, 2, v23
 s_lshl_b32 s3, s28, 7
 s_add_u32 s3, s3, 149504
 v_add_u32 v168, s3, v168
 v_lshlrev_b32 v170, 5, v27
 v_lshl_add_u32 v170, v22, 3, v170
 s_lshl_b32 s3, s28, 8
 s_add_u32 s3, s3, 153600
 v_add_u32 v170, s3, v170
 s_mov_b32 s84, 0
K1_SLOWFB_R:
 s_add_u32 s85, s84, 2
 v_readlane_b32 s76, v7, s84
 v_readlane_b32 s77, v7, s85
 s_lshl_b32 s76, s76, 6
 s_lshl_b32 s77, s77, 6
 s_nop 1
 buffer_load_dwordx4 v[128:131], v25, s[44:47], s76 offen
 buffer_load_dwordx4 v[132:135], v25, s[44:47], s77 offen
 s_waitcnt vmcnt(0)
 v_lshlrev_b32 v136, 16, v128
 v_and_b32 v137, s40, v128
 v_lshlrev_b32 v138, 16, v129
 v_and_b32 v139, s40, v129
 v_lshlrev_b32 v140, 16, v130
 v_and_b32 v141, s40, v130
 v_lshlrev_b32 v142, 16, v131
 v_and_b32 v143, s40, v131
 v_add_f32 v146, v136, v137
 v_mul_f32 v147, v136, v136
 v_fmac_f32 v147, v137, v137
 v_fmac_f32 v147, v138, v138
 v_fmac_f32 v147, v139, v139
 v_fmac_f32 v147, v140, v140
 v_fmac_f32 v147, v141, v141
 v_fmac_f32 v147, v142, v142
 v_fmac_f32 v147, v143, v143
 v_add_f32 v146, v146, v138
 v_add_f32 v146, v146, v139
 v_add_f32 v146, v146, v140
 v_add_f32 v146, v146, v141
 v_add_f32 v146, v146, v142
 v_add_f32 v146, v146, v143
 v_lshlrev_b32 v136, 16, v132
 v_and_b32 v137, s40, v132
 v_lshlrev_b32 v138, 16, v133
 v_and_b32 v139, s40, v133
 v_lshlrev_b32 v140, 16, v134
 v_and_b32 v141, s40, v134
 v_lshlrev_b32 v142, 16, v135
 v_and_b32 v143, s40, v135
 v_add_f32 v148, v136, v137
 v_mul_f32 v149, v136, v136
 v_fmac_f32 v149, v137, v137
 v_fmac_f32 v149, v138, v138
 v_fmac_f32 v149, v139, v139
 v_fmac_f32 v149, v140, v140
 v_fmac_f32 v149, v141, v141
 v_fmac_f32 v149, v142, v142
 v_fmac_f32 v149, v143, v143
 v_add_f32 v148, v148, v138
 v_add_f32 v148, v148, v139
 v_add_f32 v148, v148, v140
 v_add_f32 v148, v148, v141
 v_add_f32 v148, v148, v142
 v_add_f32 v148, v148, v143
 s_nop 1
 v_permlane32_swap_b32 v146, v148
 v_permlane32_swap_b32 v147, v149
 v_add_f32 v146, v146, v148
 v_add_f32 v147, v147, v149
 v_mov_b32 v148, v146
 v_mov_b32 v149, v147
 s_nop 0
 v_permlane16_swap_b32 v146, v148
 v_permlane16_swap_b32 v147, v149
 v_add_f32 v146, v146, v148
 v_add_f32 v147, v147, v149
 s_nop 0
 v_add_f32_dpp v146, v146, v146 row_ror:8 row_mask:0xf bank_mask:0xf
 v_add_f32_dpp v147, v147, v147 row_ror:8 row_mask:0xf bank_mask:0xf
 s_nop 0
 v_add_f32_dpp v146, v146, v146 row_ror:4 row_mask:0xf bank_mask:0xf
 v_add_f32_dpp v147, v147, v147 row_ror:4 row_mask:0xf bank_mask:0xf
 s_nop 0
 v_add_f32_dpp v146, v146, v146 row_ror:2 row_mask:0xf bank_mask:0xf
 v_add_f32_dpp v147, v147, v147 row_ror:2 row_mask:0xf bank_mask:0xf
 s_nop 0
 v_add_f32_dpp v146, v146, v146 row_ror:1 row_mask:0xf bank_mask:0xf
 v_add_f32_dpp v147, v147, v147 row_ror:1 row_mask:0xf bank_mask:0xf
 v_mul_f32 v164, 0x3b000000, v146
 v_mul_f32 v166, 0x3b000000, v147
 v_fma_f32 v166, -v164, v164, v166
 v_max_f32 v166, 0, v166
 v_cvt_pk_bf16_f32 v167, v164, v166
 v_lshlrev_b32 v164, 16, v167
 v_and_b32 v166, s40, v167
 v_add_f32 v166, 0x3727c5ac, v166
 v_cvt_pk_bf16_f32 v166, v166, v166
 v_and_b32 v166, s40, v166
 v_sqrt_f32 v166, v166
 s_nop 0
 v_cvt_pk_bf16_f32 v166, v166, v166
 v_and_b32 v166, s40, v166
 v_rcp_f32 v165, v166
 s_nop 0
 v_mul_f32 v166, v164, v165
 ds_write2_b32 v168, v164, v165 offset1:128
 v_add_u32 v168, 8, v168
 s_add_u32 s84, s84, 4
 s_cmp_lt_u32 s84, 64
 s_cbranch_scc1 K1_SLOWFB_R
 s_bitcmp1_b32 s28, 1
 s_cselect_b32 s64, s14, s12
 s_cselect_b32 s65, s15, s13
 s_mov_b32 s66, 1835008
 s_mov_b32 s67, 0x20000
 v_mul_u32_u24 v30, 3584, v26
 s_and_b32 s3, s28, 1
 s_lshl_b32 s3, s3, 7
 s_add_u32 s3, s3, s83
 v_lshlrev_b32 v31, 4, v27
 v_add3_u32 v30, v30, v31, s3
 s_mov_b32 s76, 0
 v_mov_b32 v176, 0
 v_mov_b32 v177, 0
 v_mov_b32 v178, 0
 v_mov_b32 v179, 0
 v_mov_b32 v180, 0
 v_mov_b32 v181, 0
 v_mov_b32 v182, 0
 v_mov_b32 v183, 0
K1_SLOWFB_C:
 s_nop 0
 buffer_load_dwordx4 v[136:139], v30, s[64:67], s76 offen
 s_add_u32 s76, s76, 28672
 buffer_load_dwordx4 v[140:143], v30, s[64:67], s76 offen
 s_add_u32 s76, s76, 28672
 buffer_load_dwordx4 v[144:147], v30, s[64:67], s76 offen
 s_add_u32 s76, s76, 28672
 buffer_load_dwordx4 v[148:151], v30, s[64:67], s76 offen
 s_add_u32 s76, s76, 28672
 s_waitcnt vmcnt(0)
 v_lshlrev_b32 v152, 16, v136
 v_lshlrev_b32 v153, 16, v140
 v_lshlrev_b32 v154, 16, v144
 v_lshlrev_b32 v155, 16, v148
 v_add_f32 v156, v152, v153
 v_add_f32 v154, v154, v155
 v_add_f32 v156, v156, v154
 v_and_b32 v152, s40, v136
 v_and_b32 v153, s40, v140
 v_and_b32 v154, s40, v144
 v_and_b32 v155, s40, v148
 v_add_f32 v157, v152, v153
 v_add_f32 v154, v154, v155
 v_add_f32 v157, v157, v154
 v_lshlrev_b32 v152, 16, v137
 v_lshlrev_b32 v153, 16, v141
 v_lshlrev_b32 v154, 16, v145
 v_lshlrev_b32 v155, 16, v149
 v_add_f32 v158, v152, v153
 v_add_f32 v154, v154, v155
 v_add_f32 v158, v158, v154
 v_and_b32 v152, s40, v137
 v_and_b32 v153, s40, v141
 v_and_b32 v154, s40, v145
 v_and_b32 v155, s40, v149
 v_add_f32 v159, v152, v153
 v_add_f32 v154, v154, v155
 v_add_f32 v159, v159, v154
 v_lshlrev_b32 v152, 16, v138
 v_lshlrev_b32 v153, 16, v142
 v_lshlrev_b32 v154, 16, v146
 v_lshlrev_b32 v155, 16, v150
 v_add_f32 v160, v152, v153
 v_add_f32 v154, v154, v155
 v_add_f32 v160, v160, v154
 v_and_b32 v152, s40, v138
 v_and_b32 v153, s40, v142
 v_and_b32 v154, s40, v146
 v_and_b32 v155, s40, v150
 v_add_f32 v161, v152, v153
 v_add_f32 v154, v154, v155
 v_add_f32 v161, v161, v154
 v_lshlrev_b32 v152, 16, v139
 v_lshlrev_b32 v153, 16, v143
 v_lshlrev_b32 v154, 16, v147
 v_lshlrev_b32 v155, 16, v151
 v_add_f32 v162, v152, v153
 v_add_f32 v154, v154, v155
 v_add_f32 v162, v162, v154
 v_and_b32 v152, s40, v139
 v_and_b32 v153, s40, v143
 v_and_b32 v154, s40, v147
 v_and_b32 v155, s40, v151
 v_add_f32 v163, v152, v153
 v_add_f32 v154, v154, v155
 v_add_f32 v163, v163, v154
 v_add_f32 v176, v176, v156
 v_add_f32 v177, v177, v157
 v_add_f32 v178, v178, v158
 v_add_f32 v179, v179, v159
 v_add_f32 v180, v180, v160
 v_add_f32 v181, v181, v161
 v_add_f32 v182, v182, v162
 v_add_f32 v183, v183, v163
 s_cmp_lt_u32 s76, 1835008
 s_cbranch_scc1 K1_SLOWFB_C
 v_mov_b32 v156, v176
 v_mov_b32 v157, v177
 v_mov_b32 v158, v178
 v_mov_b32 v159, v179
 v_mov_b32 v160, v180
 v_mov_b32 v161, v181
 v_mov_b32 v162, v182
 v_mov_b32 v163, v183
 v_permlane32_swap_b32 v156, v160
 v_permlane32_swap_b32 v157, v161
 v_permlane32_swap_b32 v158, v162
 v_permlane32_swap_b32 v159, v163
 v_add_f32 v156, v156, v160
 v_add_f32 v157, v157, v161
 v_add_f32 v158, v158, v162
 v_add_f32 v159, v159, v163
 s_nop 0
 v_permlane16_swap_b32 v156, v158
 v_permlane16_swap_b32 v157, v159
 v_add_f32 v156, v156, v158
 v_add_f32 v157, v157, v159
 s_nop 0
 v_add_f32_dpp v156, v156, v156 row_ror:8 row_mask:0xf bank_mask:0xf
 v_add_f32_dpp v157, v157, v157 row_ror:8 row_mask:0xf bank_mask:0xf
 ds_write_b64 v170, v[156:157]
 s_branch K1_BACKFB
K1_FFT:
 s_lshl_b32 s29, s21, 2
 s_add_u32 s29, s29, s22
 v_and_b32 v14, 15, v1
 s_lshl_b32 s76, s2, 3
 s_lshl_b32 s3, s28, 1
 s_add_u32 s76, s76, s3
 s_lshl_b32 s77, s76, 4
 s_add_u32 s77, s77, 65536
 s_lshl_b32 s76, s76, 10
 v_and_b32 v12, 1, v26
 v_lshlrev_b32 v12, 10, v12
 v_lshl_add_u32 v12, v27, 6, v12
 v_lshl_add_u32 v12, v22, 4, v12
 s_waitcnt lgkmcnt(0)
 s_mov_b32 s44, s4
 s_mov_b32 s45, s5
 s_cmp_lg_u32 s27, 0
 s_cbranch_scc1 K1_X1
 buffer_load_dwordx4 v[128:131], v12, s[44:47], s76 offen
 buffer_load_dwordx4 v[132:135], v12, s[44:47], s76 offen offset:512
K1_X1:
 s_mov_b32 s18, s74
 s_mov_b32 s19, s75
 s_mov_b32 s74, 256
 s_mov_b32 s75, 0x20000
 s_add_u32 s52, s18, 10485760
 s_addc_u32 s53, s19, 0
 s_mov_b32 s54, 2097152
 s_mov_b32 s55, 0x20000
 s_add_u32 s68, s18, 15728640
 s_addc_u32 s69, s19, 0
 s_mov_b32 s70, 196608
 s_mov_b32 s71, 0x20000
 s_load_dwordx2 s[66:67], s[68:69], 0
 v_lshrrev_b32 v2, 1, v1
 v_and_b32 v3, 1, v1
 v_lshlrev_b32 v4, 10, v2
 v_lshl_add_u32 v4, v3, 4, v4
 s_lshl_b32 s25, s20, 18
 s_lshl_b32 s3, s29, 5
 s_add_u32 s25, s25, s3
 s_cmp_eq_u32 s27, 0
 s_cbranch_scc1 K1_XR
 buffer_load_dwordx4 v[64:67], v4, s[44:47], s25 offen
 s_add_u32 s25, s25, 0x8000
 buffer_load_dwordx4 v[68:71], v4, s[44:47], s25 offen
 s_add_u32 s25, s25, 0x8000
 buffer_load_dwordx4 v[72:75], v4, s[44:47], s25 offen
 s_add_u32 s25, s25, 0x8000
 buffer_load_dwordx4 v[76:79], v4, s[44:47], s25 offen
 s_add_u32 s25, s25, 0x8000
 buffer_load_dwordx4 v[80:83], v4, s[44:47], s25 offen
 s_add_u32 s25, s25, 0x8000
 buffer_load_dwordx4 v[84:87], v4, s[44:47], s25 offen
 s_add_u32 s25, s25, 0x8000
 buffer_load_dwordx4 v[88:91], v4, s[44:47], s25 offen
 s_add_u32 s25, s25, 0x8000
 buffer_load_dwordx4 v[92:95], v4, s[44:47], s25 offen
 s_lshl_b32 s3, s28, 4
 v_add_u32 v15, s3, v14
 v_cvt_f32_u32 v16, v15
 v_cvt_f32_u32 v17, v22
 v_cvt_f32_u32 v18, v14
 v_mul_f32 v16, 0x3c800000, v16
 v_mul_f32 v18, 0x3d000000, v18
 v_mul_f32 v19, v16, v17
 v_mul_f32 v19, 0x41000000, v19
 s_mov_b32 s41, 0x80008000
 v_and_b32 v5, 1, v15
 v_mul_lo_u32 v5, v5, s41
 v_and_b32 v6, 1, v1
 v_mul_lo_u32 v6, v6, s41
 v_fmamk_f32 v200, v16, 0x00000000, v19
 v_fmamk_f32 v201, v16, 0x3f800000, v19
 v_fmamk_f32 v202, v16, 0x40000000, v19
 v_fmamk_f32 v203, v16, 0x40400000, v19
 v_fmamk_f32 v204, v16, 0x40800000, v19
 v_fmamk_f32 v205, v16, 0x40a00000, v19
 v_fmamk_f32 v206, v16, 0x40c00000, v19
 v_fmamk_f32 v207, v16, 0x40e00000, v19
 v_fract_f32 v200, v200
 v_fract_f32 v201, v201
 v_fract_f32 v202, v202
 v_fract_f32 v203, v203
 v_fract_f32 v204, v204
 v_fract_f32 v205, v205
 v_fract_f32 v206, v206
 v_fract_f32 v207, v207
 v_sin_f32 v208, v200
 v_sin_f32 v209, v201
 v_sin_f32 v210, v202
 v_sin_f32 v211, v203
 v_sin_f32 v212, v204
 v_sin_f32 v213, v205
 v_sin_f32 v214, v206
 v_sin_f32 v215, v207
 v_cos_f32 v200, v200
 v_cos_f32 v201, v201
 v_cos_f32 v202, v202
 v_cos_f32 v203, v203
 v_cos_f32 v204, v204
 v_cos_f32 v205, v205
 v_cos_f32 v206, v206
 v_cos_f32 v207, v207
 v_cvt_pk_bf16_f32 v104, v208, v209
 v_cvt_pk_bf16_f32 v105, v210, v211
 v_cvt_pk_bf16_f32 v106, v212, v213
 v_cvt_pk_bf16_f32 v107, v214, v215
 v_cvt_pk_bf16_f32 v96, v200, v201
 v_cvt_pk_bf16_f32 v97, v202, v203
 v_cvt_pk_bf16_f32 v98, v204, v205
 v_cvt_pk_bf16_f32 v99, v206, v207
 v_xor_b32 v104, s41, v104
 v_xor_b32 v105, s41, v105
 v_xor_b32 v106, s41, v106
 v_xor_b32 v107, s41, v107
 v_xor_b32 v100, v5, v96
 v_xor_b32 v101, v5, v97
 v_xor_b32 v102, v5, v98
 v_xor_b32 v103, v5, v99
 v_xor_b32 v108, v5, v104
 v_xor_b32 v109, v5, v105
 v_xor_b32 v110, v5, v106
 v_xor_b32 v111, v5, v107
 v_mul_f32 v16, 0x3d000000, v16
 v_mul_f32 v19, v16, v17
 v_mul_f32 v19, 4.0, v19
 v_fmamk_f32 v200, v16, 0x00000000, v19
 v_fmamk_f32 v201, v16, 0x3f800000, v19
 v_fmamk_f32 v202, v16, 0x40000000, v19
 v_fmamk_f32 v203, v16, 0x40400000, v19
 v_fmamk_f32 v204, v16, 0x41800000, v19
 v_fmamk_f32 v205, v16, 0x41880000, v19
 v_fmamk_f32 v206, v16, 0x41900000, v19
 v_fmamk_f32 v207, v16, 0x41980000, v19
 v_cos_f32 v112, v200
 v_cos_f32 v113, v201
 v_cos_f32 v114, v202
 v_cos_f32 v115, v203
 v_cos_f32 v116, v204
 v_cos_f32 v117, v205
 v_cos_f32 v118, v206
 v_cos_f32 v119, v207
 v_sin_f32 v120, v200
 v_sin_f32 v121, v201
 v_sin_f32 v122, v202
 v_sin_f32 v123, v203
 v_sin_f32 v124, v204
 v_sin_f32 v125, v205
 v_sin_f32 v126, v206
 v_sin_f32 v127, v207
 v_mul_f32 v19, v18, v17
 v_mul_f32 v19, 4.0, v19
 v_fmamk_f32 v200, v18, 0x00000000, v19
 v_fmamk_f32 v201, v18, 0x3f800000, v19
 v_fmamk_f32 v202, v18, 0x40000000, v19
 v_fmamk_f32 v203, v18, 0x40400000, v19
 v_fract_f32 v200, v200
 v_fract_f32 v201, v201
 v_fract_f32 v202, v202
 v_fract_f32 v203, v203
 v_sin_f32 v204, v200
 v_sin_f32 v205, v201
 v_sin_f32 v206, v202
 v_sin_f32 v207, v203
 v_cos_f32 v200, v200
 v_cos_f32 v201, v201
 v_cos_f32 v202, v202
 v_cos_f32 v203, v203
 v_cvt_pk_bf16_f32 v220, v204, v205
 v_cvt_pk_bf16_f32 v221, v206, v207
 v_cvt_pk_bf16_f32 v216, v200, v201
 v_cvt_pk_bf16_f32 v217, v202, v203
 v_xor_b32 v218, v6, v216
 v_xor_b32 v219, v6, v217
 v_xor_b32 v222, v6, v220
 v_xor_b32 v223, v6, v221
 v_xor_b32 v224, s41, v220
 v_xor_b32 v225, s41, v221
 v_xor_b32 v226, s41, v222
 v_xor_b32 v227, s41, v223
 v_mov_b32 v232, 0xbf803f80
 v_mov_b32 v233, 0xbf803f80
 v_mov_b32 v234, 0xbf803f80
 v_mov_b32 v235, 0xbf803f80
 v_lshlrev_b32 v5, 4, v2
 s_lshl_b32 s78, s20, 12
 s_add_u32 s78, s78, 65536
 v_lshrrev_b32 v6, 4, v2
 v_lshlrev_b32 v6, 11, v6
 v_and_b32 v7, 15, v2
 v_lshl_add_u32 v6, v7, 4, v6
 v_mul_u32_u24 v7, 32832, v3
 s_lshl_b32 s3, s27, 10
 s_lshl_b32 s31, s28, 8
 s_add_u32 s3, s3, s31
 v_add3_u32 v6, v6, v7, s3
 s_mul_i32 s3, s27, 32832
 v_add_u32 v7, s3, v25
 v_lshlrev_b32 v8, 19, v22
 v_lshl_add_u32 v8, v14, 4, v8
 s_lshr_b32 s38, s28, 1
 s_lshl_b32 s38, s38, 16
 s_lshl_b32 s3, s29, 11
 s_add_u32 s38, s38, s3
 s_lshl_b32 s3, s27, 9
 s_add_u32 s38, s38, s3
 s_and_b32 s3, s28, 1
 s_lshl_b32 s3, s3, 8
 s_add_u32 s38, s38, s3
 s_cmp_eq_u32 s28, 0
 s_cselect_b32 s64, 1, 0
 s_mov_b32 s65, 0
 v_mov_b32 v31, 0x1000000
 v_mov_b32 v30, 1
 v_cmp_eq_u32 vcc, 0, v0
 s_lshl_b32 s3, s2, 2
 v_mov_b32 v11, s3
 v_cndmask_b32 v11, v31, v11, vcc
 v_cndmask_b32 v24, v31, 0, vcc
 s_waitcnt lgkmcnt(0)
 s_add_u32 s66, s66, 1
 s_addc_u32 s67, s67, 0
 s_barrier
 s_barrier
 s_branch K1_XC
K1_XR:
 s_nop 0
 v_mov_b32 v172, 0x3f803f80
 v_mov_b32 v173, 0x3f803f80
 v_mov_b32 v174, 0x3f803f80
 v_mov_b32 v175, 0x3f803f80
 v_and_b32 v19, 3, v21
 v_cmp_eq_u32 s[60:61], v19, v22
 v_cmp_eq_u32 s[80:81], 1, v20
 v_cmp_lt_u32 s[58:59], 1, v20
 v_cmp_eq_u32 s[56:57], 3, v20
 v_mov_b32 v19, 0x1000000
 v_cmp_eq_u32 vcc, 0, v1
 s_nop 1
 v_cndmask_b32 v13, v19, 0, vcc
 v_cmp_eq_u32 vcc, 40, v1
 s_nop 1
 v_cndmask_b32 v13, v13, 16, vcc
 s_waitcnt vmcnt(0)
 v_mfma_f32_16x16x32_bf16 v[136:139], v[172:175], v[128:131], 0
 v_mfma_f32_16x16x32_bf16 v[140:143], v[128:131], v[128:131], 0
 v_mfma_f32_16x16x32_bf16 v[136:139], v[172:175], v[132:135], v[136:139]
 v_mfma_f32_16x16x32_bf16 v[140:143], v[132:135], v[132:135], v[140:143]
 s_nop 7
 v_cndmask_b32 v140, v140, v141, s[80:81]
 v_cndmask_b32 v142, v142, v143, s[56:57]
 v_add_f32_dpp v136, v136, v136 quad_perm:[1,0,3,2] row_mask:0xf bank_mask:0xf
 v_cndmask_b32 v140, v140, v142, s[58:59]
 s_nop 0
 v_add_f32_dpp v136, v136, v136 quad_perm:[2,3,0,1] row_mask:0xf bank_mask:0xf
 v_cndmask_b32 v140, 0, v140, s[60:61]
 s_nop 0
 v_add_f32_dpp v136, v136, v136 row_half_mirror row_mask:0xf bank_mask:0xf
 v_add_f32_dpp v140, v140, v140 row_ror:8 row_mask:0xf bank_mask:0xf
 s_nop 1
 v_add_f32_dpp v140, v140, v140 row_ror:4 row_mask:0xf bank_mask:0xf
 s_nop 1
 v_add_f32_dpp v140, v140, v140 row_ror:2 row_mask:0xf bank_mask:0xf
 s_nop 1
 v_add_f32_dpp v140, v140, v140 row_ror:1 row_mask:0xf bank_mask:0xf
 v_mov_b32 v141, v140
 s_nop 1
 v_permlane16_swap_b32 v140, v141
 v_add_f32 v140, v140, v141
 v_mul_f32 v164, 0x3b000000, v136
 v_mul_f32 v166, 0x3b000000, v140
 v_fma_f32 v166, -v164, v164, v166
 v_max_f32 v166, 0, v166
 v_cvt_pk_bf16_f32 v167, v164, v166
 v_lshlrev_b32 v164, 16, v167
 v_and_b32 v166, s40, v167
 v_add_f32 v166, 0x3727c5ac, v166
 v_cvt_pk_bf16_f32 v166, v166, v166
 v_and_b32 v166, s40, v166
 v_sqrt_f32 v166, v166
 s_nop 0
 v_cvt_pk_bf16_f32 v166, v166, v166
 v_and_b32 v166, s40, v166
 v_rcp_f32 v165, v166
 s_waitcnt lgkmcnt(0)
 s_add_u32 s66, s66, 1
 s_addc_u32 s67, s67, 0
 v_mov_b32 v166, s66
 v_mov_b32 v167, s67
 s_barrier
 buffer_store_dwordx4 v[164:167], v13, s[68:71], s77 offen sc1
 buffer_load_dwordx4 v[64:67], v4, s[44:47], s25 offen
 s_add_u32 s25, s25, 0x8000
 buffer_load_dwordx4 v[68:71], v4, s[44:47], s25 offen
 s_add_u32 s25, s25, 0x8000
 buffer_load_dwordx4 v[72:75], v4, s[44:47], s25 offen
 s_add_u32 s25, s25, 0x8000
 buffer_load_dwordx4 v[76:79], v4, s[44:47], s25 offen
 s_add_u32 s25, s25, 0x8000
 buffer_load_dwordx4 v[80:83], v4, s[44:47], s25 offen
 s_add_u32 s25, s25, 0x8000
 buffer_load_dwordx4 v[84:87], v4, s[44:47], s25 offen
 s_add_u32 s25, s25, 0x8000
 buffer_load_dwordx4 v[88:91], v4, s[44:47], s25 offen
 s_add_u32 s25, s25, 0x8000
 buffer_load_dwordx4 v[92:95], v4, s[44:47], s25 offen
 s_lshl_b32 s3, s28, 4
 v_add_u32 v15, s3, v14
 v_cvt_f32_u32 v16, v15
 v_cvt_f32_u32 v17, v22
 v_cvt_f32_u32 v18, v14
 v_mul_f32 v16, 0x3c800000, v16
 v_mul_f32 v18, 0x3d000000, v18
 v_mul_f32 v19, v16, v17
 v_mul_f32 v19, 0x41000000, v19
 s_mov_b32 s41, 0x80008000
 v_and_b32 v5, 1, v15
 v_mul_lo_u32 v5, v5, s41
 v_and_b32 v6, 1, v1
 v_mul_lo_u32 v6, v6, s41
 v_fmamk_f32 v200, v16, 0x00000000, v19
 v_fmamk_f32 v201, v16, 0x3f800000, v19
 v_fmamk_f32 v202, v16, 0x40000000, v19
 v_fmamk_f32 v203, v16, 0x40400000, v19
 v_fmamk_f32 v204, v16, 0x40800000, v19
 v_fmamk_f32 v205, v16, 0x40a00000, v19
 v_fmamk_f32 v206, v16, 0x40c00000, v19
 v_fmamk_f32 v207, v16, 0x40e00000, v19
 v_fract_f32 v200, v200
 v_fract_f32 v201, v201
 v_fract_f32 v202, v202
 v_fract_f32 v203, v203
 v_fract_f32 v204, v204
 v_fract_f32 v205, v205
 v_fract_f32 v206, v206
 v_fract_f32 v207, v207
 v_sin_f32 v208, v200
 v_sin_f32 v209, v201
 v_sin_f32 v210, v202
 v_sin_f32 v211, v203
 v_sin_f32 v212, v204
 v_sin_f32 v213, v205
 v_sin_f32 v214, v206
 v_sin_f32 v215, v207
 v_cos_f32 v200, v200
 v_cos_f32 v201, v201
 v_cos_f32 v202, v202
 v_cos_f32 v203, v203
 v_cos_f32 v204, v204
 v_cos_f32 v205, v205
 v_cos_f32 v206, v206
 v_cos_f32 v207, v207
 v_cvt_pk_bf16_f32 v104, v208, v209
 v_cvt_pk_bf16_f32 v105, v210, v211
 v_cvt_pk_bf16_f32 v106, v212, v213
 v_cvt_pk_bf16_f32 v107, v214, v215
 v_cvt_pk_bf16_f32 v96, v200, v201
 v_cvt_pk_bf16_f32 v97, v202, v203
 v_cvt_pk_bf16_f32 v98, v204, v205
 v_cvt_pk_bf16_f32 v99, v206, v207
 v_xor_b32 v104, s41, v104
 v_xor_b32 v105, s41, v105
 v_xor_b32 v106, s41, v106
 v_xor_b32 v107, s41, v107
 v_xor_b32 v100, v5, v96
 v_xor_b32 v101, v5, v97
 v_xor_b32 v102, v5, v98
 v_xor_b32 v103, v5, v99
 v_xor_b32 v108, v5, v104
 v_xor_b32 v109, v5, v105
 v_xor_b32 v110, v5, v106
 v_xor_b32 v111, v5, v107
 v_mul_f32 v16, 0x3d000000, v16
 v_mul_f32 v19, v16, v17
 v_mul_f32 v19, 4.0, v19
 v_fmamk_f32 v200, v16, 0x00000000, v19
 v_fmamk_f32 v201, v16, 0x3f800000, v19
 v_fmamk_f32 v202, v16, 0x40000000, v19
 v_fmamk_f32 v203, v16, 0x40400000, v19
 v_fmamk_f32 v204, v16, 0x41800000, v19
 v_fmamk_f32 v205, v16, 0x41880000, v19
 v_fmamk_f32 v206, v16, 0x41900000, v19
 v_fmamk_f32 v207, v16, 0x41980000, v19
 v_cos_f32 v112, v200
 v_cos_f32 v113, v201
 v_cos_f32 v114, v202
 v_cos_f32 v115, v203
 v_cos_f32 v116, v204
 v_cos_f32 v117, v205
 v_cos_f32 v118, v206
 v_cos_f32 v119, v207
 v_sin_f32 v120, v200
 v_sin_f32 v121, v201
 v_sin_f32 v122, v202
 v_sin_f32 v123, v203
 v_sin_f32 v124, v204
 v_sin_f32 v125, v205
 v_sin_f32 v126, v206
 v_sin_f32 v127, v207
 v_mul_f32 v19, v18, v17
 v_mul_f32 v19, 4.0, v19
 v_fmamk_f32 v200, v18, 0x00000000, v19
 v_fmamk_f32 v201, v18, 0x3f800000, v19
 v_fmamk_f32 v202, v18, 0x40000000, v19
 v_fmamk_f32 v203, v18, 0x40400000, v19
 v_fract_f32 v200, v200
 v_fract_f32 v201, v201
 v_fract_f32 v202, v202
 v_fract_f32 v203, v203
 v_sin_f32 v204, v200
 v_sin_f32 v205, v201
 v_sin_f32 v206, v202
 v_sin_f32 v207, v203
 v_cos_f32 v200, v200
 v_cos_f32 v201, v201
 v_cos_f32 v202, v202
 v_cos_f32 v203, v203
 v_cvt_pk_bf16_f32 v220, v204, v205
 v_cvt_pk_bf16_f32 v221, v206, v207
 v_cvt_pk_bf16_f32 v216, v200, v201
 v_cvt_pk_bf16_f32 v217, v202, v203
 v_xor_b32 v218, v6, v216
 v_xor_b32 v219, v6, v217
 v_xor_b32 v222, v6, v220
 v_xor_b32 v223, v6, v221
 v_xor_b32 v224, s41, v220
 v_xor_b32 v225, s41, v221
 v_xor_b32 v226, s41, v222
 v_xor_b32 v227, s41, v223
 v_mov_b32 v232, 0xbf803f80
 v_mov_b32 v233, 0xbf803f80
 v_mov_b32 v234, 0xbf803f80
 v_mov_b32 v235, 0xbf803f80
 v_lshlrev_b32 v5, 4, v2
 s_lshl_b32 s78, s20, 12
 s_add_u32 s78, s78, 65536
 v_lshrrev_b32 v6, 4, v2
 v_lshlrev_b32 v6, 11, v6
 v_and_b32 v7, 15, v2
 v_lshl_add_u32 v6, v7, 4, v6
 v_mul_u32_u24 v7, 32832, v3
 s_lshl_b32 s3, s27, 10
 s_lshl_b32 s31, s28, 8
 s_add_u32 s3, s3, s31
 v_add3_u32 v6, v6, v7, s3
 s_mul_i32 s3, s27, 32832
 v_add_u32 v7, s3, v25
 v_lshlrev_b32 v8, 19, v22
 v_lshl_add_u32 v8, v14, 4, v8
 s_lshr_b32 s38, s28, 1
 s_lshl_b32 s38, s38, 16
 s_lshl_b32 s3, s29, 11
 s_add_u32 s38, s38, s3
 s_lshl_b32 s3, s27, 9
 s_add_u32 s38, s38, s3
 s_and_b32 s3, s28, 1
 s_lshl_b32 s3, s3, 8
 s_add_u32 s38, s38, s3
 s_cmp_eq_u32 s28, 0
 s_cselect_b32 s64, 1, 0
 s_mov_b32 s65, 0
 v_mov_b32 v31, 0x1000000
 v_mov_b32 v30, 1
 v_cmp_eq_u32 vcc, 0, v0
 s_lshl_b32 s3, s2, 2
 v_mov_b32 v11, s3
 v_cndmask_b32 v11, v31, v11, vcc
 v_cndmask_b32 v24, v31, 0, vcc
 s_waitcnt vmcnt(8)
 s_barrier
 buffer_atomic_add v30, v11, s[72:75], 0 offen sc1
K1_XC:
 s_mov_b32 s39, 0
 s_movk_i32 s82, 0xff
 s_mov_b32 s83, 0
K1_XP:
 s_nop 0
 s_bitcmp1_b32 s82, 0
 s_cbranch_scc0 K1_XP0
 buffer_load_dwordx4 v[32:35], v5, s[68:71], s78 offen offset:0 sc1
K1_XP0:
 s_bitcmp1_b32 s82, 1
 s_cbranch_scc0 K1_XP1
 buffer_load_dwordx4 v[36:39], v5, s[68:71], s78 offen offset:512 sc1
K1_XP1:
 s_bitcmp1_b32 s82, 2
 s_cbranch_scc0 K1_XP2
 buffer_load_dwordx4 v[40:43], v5, s[68:71], s78 offen offset:1024 sc1
K1_XP2:
 s_bitcmp1_b32 s82, 3
 s_cbranch_scc0 K1_XP3
 buffer_load_dwordx4 v[44:47], v5, s[68:71], s78 offen offset:1536 sc1
K1_XP3:
 s_bitcmp1_b32 s82, 4
 s_cbranch_scc0 K1_XP4
 buffer_load_dwordx4 v[48:51], v5, s[68:71], s78 offen offset:2048 sc1
K1_XP4:
 s_bitcmp1_b32 s82, 5
 s_cbranch_scc0 K1_XP5
 buffer_load_dwordx4 v[52:55], v5, s[68:71], s78 offen offset:2560 sc1
K1_XP5:
 s_bitcmp1_b32 s82, 6
 s_cbranch_scc0 K1_XP6
 buffer_load_dwordx4 v[56:59], v5, s[68:71], s78 offen offset:3072 sc1
K1_XP6:
 s_bitcmp1_b32 s82, 7
 s_cbranch_scc0 K1_XP7
 buffer_load_dwordx4 v[60:63], v5, s[68:71], s78 offen offset:3584 sc1
K1_XP7:
 s_cmp_lg_u32 s83, 0
 s_cbranch_scc1 K1_XU
 s_waitcnt vmcnt(8)
 v_lshlrev_b32 v128, 16, v64
 v_and_b32 v129, s40, v64
 v_lshlrev_b32 v130, 16, v65
 v_and_b32 v131, s40, v65
 v_lshlrev_b32 v132, 16, v66
 v_and_b32 v133, s40, v66
 v_lshlrev_b32 v134, 16, v67
 v_and_b32 v135, s40, v67
 v_lshlrev_b32 v136, 16, v68
 v_and_b32 v137, s40, v68
 v_lshlrev_b32 v138, 16, v69
 v_and_b32 v139, s40, v69
 v_lshlrev_b32 v140, 16, v70
 v_and_b32 v141, s40, v70
 v_lshlrev_b32 v142, 16, v71
 v_and_b32 v143, s40, v71
 v_lshlrev_b32 v144, 16, v72
 v_and_b32 v145, s40, v72
 v_lshlrev_b32 v146, 16, v73
 v_and_b32 v147, s40, v73
 v_lshlrev_b32 v148, 16, v74
 v_and_b32 v149, s40, v74
 v_lshlrev_b32 v150, 16, v75
 v_and_b32 v151, s40, v75
 v_lshlrev_b32 v152, 16, v76
 v_and_b32 v153, s40, v76
 v_lshlrev_b32 v154, 16, v77
 v_and_b32 v155, s40, v77
 v_lshlrev_b32 v156, 16, v78
 v_and_b32 v157, s40, v78
 v_lshlrev_b32 v158, 16, v79
 v_and_b32 v159, s40, v79
 v_lshlrev_b32 v160, 16, v80
 v_and_b32 v161, s40, v80
 v_lshlrev_b32 v162, 16, v81
 v_and_b32 v163, s40, v81
 v_lshlrev_b32 v164, 16, v82
 v_and_b32 v165, s40, v82
 v_lshlrev_b32 v166, 16, v83
 v_and_b32 v167, s40, v83
 v_lshlrev_b32 v168, 16, v84
 v_and_b32 v169, s40, v84
 v_lshlrev_b32 v170, 16, v85
 v_and_b32 v171, s40, v85
 v_lshlrev_b32 v172, 16, v86
 v_and_b32 v173, s40, v86
 v_lshlrev_b32 v174, 16, v87
 v_and_b32 v175, s40, v87
 v_lshlrev_b32 v176, 16, v88
 v_and_b32 v177, s40, v88
 v_lshlrev_b32 v178, 16, v89
 v_and_b32 v179, s40, v89
 v_lshlrev_b32 v180, 16, v90
 v_and_b32 v181, s40, v90
 v_lshlrev_b32 v182, 16, v91
 v_and_b32 v183, s40, v91
 v_lshlrev_b32 v184, 16, v92
 v_and_b32 v185, s40, v92
 v_lshlrev_b32 v186, 16, v93
 v_and_b32 v187, s40, v93
 v_lshlrev_b32 v188, 16, v94
 v_and_b32 v189, s40, v94
 v_lshlrev_b32 v190, 16, v95
 v_and_b32 v191, s40, v95
K1_XU:
 s_waitcnt vmcnt(0)
 s_mov_b32 s82, 0
 v_cmp_ne_u64 vcc, s[66:67], v[34:35]
 s_nop 0
 s_cmp_lg_u64 vcc, 0
 s_cselect_b32 s3, 1, 0
 s_or_b32 s82, s82, s3
 v_cmp_ne_u64 vcc, s[66:67], v[38:39]
 s_nop 0
 s_cmp_lg_u64 vcc, 0
 s_cselect_b32 s3, 2, 0
 s_or_b32 s82, s82, s3
 v_cmp_ne_u64 vcc, s[66:67], v[42:43]
 s_nop 0
 s_cmp_lg_u64 vcc, 0
 s_cselect_b32 s3, 4, 0
 s_or_b32 s82, s82, s3
 v_cmp_ne_u64 vcc, s[66:67], v[46:47]
 s_nop 0
 s_cmp_lg_u64 vcc, 0
 s_cselect_b32 s3, 8, 0
 s_or_b32 s82, s82, s3
 v_cmp_ne_u64 vcc, s[66:67], v[50:51]
 s_nop 0
 s_cmp_lg_u64 vcc, 0
 s_cselect_b32 s3, 16, 0
 s_or_b32 s82, s82, s3
 v_cmp_ne_u64 vcc, s[66:67], v[54:55]
 s_nop 0
 s_cmp_lg_u64 vcc, 0
 s_cselect_b32 s3, 32, 0
 s_or_b32 s82, s82, s3
 v_cmp_ne_u64 vcc, s[66:67], v[58:59]
 s_nop 0
 s_cmp_lg_u64 vcc, 0
 s_cselect_b32 s3, 64, 0
 s_or_b32 s82, s82, s3
 v_cmp_ne_u64 vcc, s[66:67], v[62:63]
 s_nop 0
 s_cmp_lg_u64 vcc, 0
 s_cselect_b32 s3, 128, 0
 s_or_b32 s82, s82, s3
 s_cbranch_scc0 K1_XBACK
 s_add_u32 s83, s83, 1
 s_cmp_ge_u32 s83, 300
 s_cbranch_scc1 K1_XSLOW
 s_sleep 8
 s_branch K1_XP
K1_XBACK:
 s_nop 0
 v_mul_f32 v32, v32, v33
 v_mul_f32 v36, v36, v37
 v_mul_f32 v40, v40, v41
 v_mul_f32 v44, v44, v45
 v_mul_f32 v48, v48, v49
 v_mul_f32 v52, v52, v53
 v_mul_f32 v56, v56, v57
 v_mul_f32 v60, v60, v61
 v_pk_fma_f32 v[128:129], v[128:129], v[32:33], v[32:33] op_sel:[0,1,0] op_sel_hi:[1,1,0] neg_lo:[0,0,1] neg_hi:[0,0,1]
 v_pk_fma_f32 v[130:131], v[130:131], v[32:33], v[32:33] op_sel:[0,1,0] op_sel_hi:[1,1,0] neg_lo:[0,0,1] neg_hi:[0,0,1]
 v_pk_fma_f32 v[132:133], v[132:133], v[32:33], v[32:33] op_sel:[0,1,0] op_sel_hi:[1,1,0] neg_lo:[0,0,1] neg_hi:[0,0,1]
 v_pk_fma_f32 v[134:135], v[134:135], v[32:33], v[32:33] op_sel:[0,1,0] op_sel_hi:[1,1,0] neg_lo:[0,0,1] neg_hi:[0,0,1]
 v_pk_fma_f32 v[136:137], v[136:137], v[36:37], v[36:37] op_sel:[0,1,0] op_sel_hi:[1,1,0] neg_lo:[0,0,1] neg_hi:[0,0,1]
 v_pk_fma_f32 v[138:139], v[138:139], v[36:37], v[36:37] op_sel:[0,1,0] op_sel_hi:[1,1,0] neg_lo:[0,0,1] neg_hi:[0,0,1]
 v_pk_fma_f32 v[140:141], v[140:141], v[36:37], v[36:37] op_sel:[0,1,0] op_sel_hi:[1,1,0] neg_lo:[0,0,1] neg_hi:[0,0,1]
 v_pk_fma_f32 v[142:143], v[142:143], v[36:37], v[36:37] op_sel:[0,1,0] op_sel_hi:[1,1,0] neg_lo:[0,0,1] neg_hi:[0,0,1]
 v_cvt_pk_bf16_f32 v64, v128, v136
 v_cvt_pk_bf16_f32 v68, v129, v137
 v_cvt_pk_bf16_f32 v72, v130, v138
 v_cvt_pk_bf16_f32 v76, v131, v139
 v_cvt_pk_bf16_f32 v80, v132, v140
 v_cvt_pk_bf16_f32 v84, v133, v141
 v_cvt_pk_bf16_f32 v88, v134, v142
 v_cvt_pk_bf16_f32 v92, v135, v143
 v_pk_fma_f32 v[144:145], v[144:145], v[40:41], v[40:41] op_sel:[0,1,0] op_sel_hi:[1,1,0] neg_lo:[0,0,1] neg_hi:[0,0,1]
 v_pk_fma_f32 v[146:147], v[146:147], v[40:41], v[40:41] op_sel:[0,1,0] op_sel_hi:[1,1,0] neg_lo:[0,0,1] neg_hi:[0,0,1]
 v_pk_fma_f32 v[148:149], v[148:149], v[40:41], v[40:41] op_sel:[0,1,0] op_sel_hi:[1,1,0] neg_lo:[0,0,1] neg_hi:[0,0,1]
 v_pk_fma_f32 v[150:151], v[150:151], v[40:41], v[40:41] op_sel:[0,1,0] op_sel_hi:[1,1,0] neg_lo:[0,0,1] neg_hi:[0,0,1]
 v_pk_fma_f32 v[152:153], v[152:153], v[44:45], v[44:45] op_sel:[0,1,0] op_sel_hi:[1,1,0] neg_lo:[0,0,1] neg_hi:[0,0,1]
 v_pk_fma_f32 v[154:155], v[154:155], v[44:45], v[44:45] op_sel:[0,1,0] op_sel_hi:[1,1,0] neg_lo:[0,0,1] neg_hi:[0,0,1]
 v_pk_fma_f32 v[156:157], v[156:157], v[44:45], v[44:45] op_sel:[0,1,0] op_sel_hi:[1,1,0] neg_lo:[0,0,1] neg_hi:[0,0,1]
 v_pk_fma_f32 v[158:159], v[158:159], v[44:45], v[44:45] op_sel:[0,1,0] op_sel_hi:[1,1,0] neg_lo:[0,0,1] neg_hi:[0,0,1]
 v_cvt_pk_bf16_f32 v65, v144, v152
 v_cvt_pk_bf16_f32 v69, v145, v153
 v_cvt_pk_bf16_f32 v73, v146, v154
 v_cvt_pk_bf16_f32 v77, v147, v155
 v_cvt_pk_bf16_f32 v81, v148, v156
 v_cvt_pk_bf16_f32 v85, v149, v157
 v_cvt_pk_bf16_f32 v89, v150, v158
 v_cvt_pk_bf16_f32 v93, v151, v159
 v_pk_fma_f32 v[160:161], v[160:161], v[48:49], v[48:49] op_sel:[0,1,0] op_sel_hi:[1,1,0] neg_lo:[0,0,1] neg_hi:[0,0,1]
 v_pk_fma_f32 v[162:163], v[162:163], v[48:49], v[48:49] op_sel:[0,1,0] op_sel_hi:[1,1,0] neg_lo:[0,0,1] neg_hi:[0,0,1]
 v_pk_fma_f32 v[164:165], v[164:165], v[48:49], v[48:49] op_sel:[0,1,0] op_sel_hi:[1,1,0] neg_lo:[0,0,1] neg_hi:[0,0,1]
 v_pk_fma_f32 v[166:167], v[166:167], v[48:49], v[48:49] op_sel:[0,1,0] op_sel_hi:[1,1,0] neg_lo:[0,0,1] neg_hi:[0,0,1]
 v_pk_fma_f32 v[168:169], v[168:169], v[52:53], v[52:53] op_sel:[0,1,0] op_sel_hi:[1,1,0] neg_lo:[0,0,1] neg_hi:[0,0,1]
 v_pk_fma_f32 v[170:171], v[170:171], v[52:53], v[52:53] op_sel:[0,1,0] op_sel_hi:[1,1,0] neg_lo:[0,0,1] neg_hi:[0,0,1]
 v_pk_fma_f32 v[172:173], v[172:173], v[52:53], v[52:53] op_sel:[0,1,0] op_sel_hi:[1,1,0] neg_lo:[0,0,1] neg_hi:[0,0,1]
 v_pk_fma_f32 v[174:175], v[174:175], v[52:53], v[52:53] op_sel:[0,1,0] op_sel_hi:[1,1,0] neg_lo:[0,0,1] neg_hi:[0,0,1]
 v_cvt_pk_bf16_f32 v66, v160, v168
 v_cvt_pk_bf16_f32 v70, v161, v169
 v_cvt_pk_bf16_f32 v74, v162, v170
 v_cvt_pk_bf16_f32 v78, v163, v171
 v_cvt_pk_bf16_f32 v82, v164, v172
 v_cvt_pk_bf16_f32 v86, v165, v173
 v_cvt_pk_bf16_f32 v90, v166, v174
 v_cvt_pk_bf16_f32 v94, v167, v175
 v_pk_fma_f32 v[176:177], v[176:177], v[56:57], v[56:57] op_sel:[0,1,0] op_sel_hi:[1,1,0] neg_lo:[0,0,1] neg_hi:[0,0,1]
 v_pk_fma_f32 v[178:179], v[178:179], v[56:57], v[56:57] op_sel:[0,1,0] op_sel_hi:[1,1,0] neg_lo:[0,0,1] neg_hi:[0,0,1]
 v_pk_fma_f32 v[180:181], v[180:181], v[56:57], v[56:57] op_sel:[0,1,0] op_sel_hi:[1,1,0] neg_lo:[0,0,1] neg_hi:[0,0,1]
 v_pk_fma_f32 v[182:183], v[182:183], v[56:57], v[56:57] op_sel:[0,1,0] op_sel_hi:[1,1,0] neg_lo:[0,0,1] neg_hi:[0,0,1]
 v_pk_fma_f32 v[184:185], v[184:185], v[60:61], v[60:61] op_sel:[0,1,0] op_sel_hi:[1,1,0] neg_lo:[0,0,1] neg_hi:[0,0,1]
 v_pk_fma_f32 v[186:187], v[186:187], v[60:61], v[60:61] op_sel:[0,1,0] op_sel_hi:[1,1,0] neg_lo:[0,0,1] neg_hi:[0,0,1]
 v_pk_fma_f32 v[188:189], v[188:189], v[60:61], v[60:61] op_sel:[0,1,0] op_sel_hi:[1,1,0] neg_lo:[0,0,1] neg_hi:[0,0,1]
 v_pk_fma_f32 v[190:191], v[190:191], v[60:61], v[60:61] op_sel:[0,1,0] op_sel_hi:[1,1,0] neg_lo:[0,0,1] neg_hi:[0,0,1]
 v_cvt_pk_bf16_f32 v67, v176, v184
 v_cvt_pk_bf16_f32 v71, v177, v185
 v_cvt_pk_bf16_f32 v75, v178, v186
 v_cvt_pk_bf16_f32 v79, v179, v187
 v_cvt_pk_bf16_f32 v83, v180, v188
 v_cvt_pk_bf16_f32 v87, v181, v189
 v_cvt_pk_bf16_f32 v91, v182, v190
 v_cvt_pk_bf16_f32 v95, v183, v191
 ds_write_b128 v6, v[64:67] offset:0
 ds_write_b128 v6, v[68:71] offset:4096
 ds_write_b128 v6, v[72:75] offset:8192
 ds_write_b128 v6, v[76:79] offset:12288
 ds_write_b128 v6, v[80:83] offset:16384
 ds_write_b128 v6, v[84:87] offset:20480
 ds_write_b128 v6, v[88:91] offset:24576
 ds_write_b128 v6, v[92:95] offset:28672
 s_waitcnt lgkmcnt(0)
 s_barrier
 ds_read_b128 v[64:67], v7 offset:0
 ds_read_b128 v[68:71], v7 offset:1024
 ds_read_b128 v[72:75], v7 offset:2048
 ds_read_b128 v[76:79], v7 offset:3072
 ds_read_b128 v[80:83], v7 offset:4096
 ds_read_b128 v[84:87], v7 offset:5120
 ds_read_b128 v[88:91], v7 offset:6144
 ds_read_b128 v[92:95], v7 offset:7168
 s_waitcnt lgkmcnt(7)
 v_mfma_f32_16x16x32_bf16 v[168:171], v[64:67], v[96:99], 0
 v_mfma_f32_16x16x32_bf16 v[176:179], v[64:67], v[104:107], 0
 s_waitcnt lgkmcnt(5)
 v_mfma_f32_16x16x32_bf16 v[172:175], v[72:75], v[96:99], 0
 v_mfma_f32_16x16x32_bf16 v[180:183], v[72:75], v[104:107], 0
 v_mfma_f32_16x16x32_bf16 v[168:171], v[68:71], v[100:103], v[168:171]
 v_mfma_f32_16x16x32_bf16 v[176:179], v[68:71], v[108:111], v[176:179]
 s_waitcnt lgkmcnt(4)
 v_mfma_f32_16x16x32_bf16 v[172:175], v[76:79], v[100:103], v[172:175]
 v_mfma_f32_16x16x32_bf16 v[180:183], v[76:79], v[108:111], v[180:183]
 s_waitcnt lgkmcnt(3)
 v_mfma_f32_16x16x32_bf16 v[184:187], v[80:83], v[96:99], 0
 s_nop 1
 v_mul_f32 v200, v168, v112
 v_mul_f32 v201, v169, v113
 v_mul_f32 v202, v170, v114
 v_mul_f32 v203, v171, v115
 v_mul_f32 v204, v172, v116
 v_mfma_f32_16x16x32_bf16 v[192:195], v[80:83], v[104:107], 0
 v_mul_f32 v205, v173, v117
 v_mul_f32 v206, v174, v118
 v_mul_f32 v207, v175, v119
 v_mul_f32 v208, v176, v112
 v_mul_f32 v209, v177, v113
 s_waitcnt lgkmcnt(1)
 v_mfma_f32_16x16x32_bf16 v[188:191], v[88:91], v[96:99], 0
 v_mul_f32 v210, v178, v114
 v_mul_f32 v211, v179, v115
 v_mul_f32 v212, v180, v116
 v_mul_f32 v213, v181, v117
 v_mul_f32 v214, v182, v118
 v_mfma_f32_16x16x32_bf16 v[196:199], v[88:91], v[104:107], 0
 v_mul_f32 v215, v183, v119
 v_fmac_f32 v200, v176, v120
 v_fmac_f32 v201, v177, v121
 v_fmac_f32 v202, v178, v122
 v_fmac_f32 v203, v179, v123
 v_mfma_f32_16x16x32_bf16 v[184:187], v[84:87], v[100:103], v[184:187]
 v_fmac_f32 v204, v180, v124
 v_fmac_f32 v205, v181, v125
 v_fmac_f32 v206, v182, v126
 v_fmac_f32 v207, v183, v127
 v_fma_f32 v208, -v168, v120, v208
 v_mfma_f32_16x16x32_bf16 v[192:195], v[84:87], v[108:111], v[192:195]
 v_fma_f32 v209, -v169, v121, v209
 v_fma_f32 v210, -v170, v122, v210
 v_fma_f32 v211, -v171, v123, v211
 v_fma_f32 v212, -v172, v124, v212
 v_fma_f32 v213, -v173, v125, v213
 s_waitcnt lgkmcnt(0)
 v_mfma_f32_16x16x32_bf16 v[188:191], v[92:95], v[100:103], v[188:191]
 v_fma_f32 v214, -v174, v126, v214
 v_fma_f32 v215, -v175, v127, v215
 v_cvt_pk_bf16_f32 v152, v200, v201
 v_cvt_pk_bf16_f32 v153, v202, v203
 v_cvt_pk_bf16_f32 v154, v204, v205
 v_mfma_f32_16x16x32_bf16 v[196:199], v[92:95], v[108:111], v[196:199]
 v_cvt_pk_bf16_f32 v155, v206, v207
 v_cvt_pk_bf16_f32 v156, v208, v209
 v_cvt_pk_bf16_f32 v157, v210, v211
 v_cvt_pk_bf16_f32 v158, v212, v213
 v_cvt_pk_bf16_f32 v159, v214, v215
 ds_read_b128 v[64:67], v7 offset:8192
 ds_read_b128 v[68:71], v7 offset:9216
 ds_read_b128 v[72:75], v7 offset:10240
 ds_read_b128 v[76:79], v7 offset:11264
 v_mfma_f32_16x16x32_bf16 v[128:131], v[216:219], v[152:155], 0
 v_mfma_f32_16x16x32_bf16 v[132:135], v[224:227], v[152:155], 0
 v_mfma_f32_16x16x32_bf16 v[136:139], v[232:235], v[152:155], 0
 v_mfma_f32_16x16x32_bf16 v[128:131], v[220:223], v[156:159], v[128:131]
 v_mfma_f32_16x16x32_bf16 v[132:135], v[216:219], v[156:159], v[132:135]
 s_waitcnt lgkmcnt(3)
 v_mfma_f32_16x16x32_bf16 v[168:171], v[64:67], v[96:99], 0
 v_mul_f32 v200, v184, v112
 v_mul_f32 v201, v185, v113
 v_mul_f32 v202, v186, v114
 v_mul_f32 v203, v187, v115
 v_mul_f32 v204, v188, v116
 v_mfma_f32_16x16x32_bf16 v[176:179], v[64:67], v[104:107], 0
 v_mul_f32 v205, v189, v117
 v_mul_f32 v206, v190, v118
 v_mul_f32 v207, v191, v119
 v_mul_f32 v208, v192, v112
 v_mul_f32 v209, v193, v113
 s_waitcnt lgkmcnt(1)
 v_mfma_f32_16x16x32_bf16 v[172:175], v[72:75], v[96:99], 0
 v_mul_f32 v210, v194, v114
 v_mul_f32 v211, v195, v115
 v_mul_f32 v212, v196, v116
 v_mul_f32 v213, v197, v117
 v_mul_f32 v214, v198, v118
 v_mfma_f32_16x16x32_bf16 v[180:183], v[72:75], v[104:107], 0
 v_mul_f32 v215, v199, v119
 v_fmac_f32 v200, v192, v120
 v_fmac_f32 v201, v193, v121
 v_fmac_f32 v202, v194, v122
 v_fmac_f32 v203, v195, v123
 v_mfma_f32_16x16x32_bf16 v[168:171], v[68:71], v[100:103], v[168:171]
 v_fmac_f32 v204, v196, v124
 v_fmac_f32 v205, v197, v125
 v_fmac_f32 v206, v198, v126
 v_fmac_f32 v207, v199, v127
 v_fma_f32 v208, -v184, v120, v208
 v_mfma_f32_16x16x32_bf16 v[176:179], v[68:71], v[108:111], v[176:179]
 v_fma_f32 v209, -v185, v121, v209
 v_fma_f32 v210, -v186, v122, v210
 v_fma_f32 v211, -v187, v123, v211
 v_fma_f32 v212, -v188, v124, v212
 v_fma_f32 v213, -v189, v125, v213
 s_waitcnt lgkmcnt(0)
 v_mfma_f32_16x16x32_bf16 v[172:175], v[76:79], v[100:103], v[172:175]
 v_fma_f32 v214, -v190, v126, v214
 v_fma_f32 v215, -v191, v127, v215
 v_cvt_pk_bf16_f32 v152, v200, v201
 v_cvt_pk_bf16_f32 v153, v202, v203
 v_cvt_pk_bf16_f32 v154, v204, v205
 v_mfma_f32_16x16x32_bf16 v[180:183], v[76:79], v[108:111], v[180:183]
 v_cvt_pk_bf16_f32 v155, v206, v207
 v_cvt_pk_bf16_f32 v156, v208, v209
 v_cvt_pk_bf16_f32 v157, v210, v211
 v_cvt_pk_bf16_f32 v158, v212, v213
 v_cvt_pk_bf16_f32 v159, v214, v215
 ds_read_b128 v[80:83], v7 offset:12288
 ds_read_b128 v[84:87], v7 offset:13312
 ds_read_b128 v[88:91], v7 offset:14336
 ds_read_b128 v[92:95], v7 offset:15360
 v_mfma_f32_16x16x32_bf16 v[140:143], v[216:219], v[152:155], 0
 v_mfma_f32_16x16x32_bf16 v[144:147], v[224:227], v[152:155], 0
 v_mfma_f32_16x16x32_bf16 v[148:151], v[232:235], v[152:155], 0
 v_mfma_f32_16x16x32_bf16 v[140:143], v[220:223], v[156:159], v[140:143]
 v_mfma_f32_16x16x32_bf16 v[144:147], v[216:219], v[156:159], v[144:147]
 s_waitcnt lgkmcnt(3)
 v_mfma_f32_16x16x32_bf16 v[184:187], v[80:83], v[96:99], 0
 v_cndmask_b32 v132, v132, v136, s[64:65]
 s_nop 4
 v_cndmask_b32 v144, v144, v148, s[64:65]
 v_cvt_pk_bf16_f32 v32, v128, v140
 v_cvt_pk_bf16_f32 v48, v132, v144
 v_cvt_pk_bf16_f32 v36, v129, v141
 v_cvt_pk_bf16_f32 v52, v133, v145
 v_mfma_f32_16x16x32_bf16 v[192:195], v[80:83], v[104:107], 0
 v_cvt_pk_bf16_f32 v40, v130, v142
 v_cvt_pk_bf16_f32 v56, v134, v146
 v_cvt_pk_bf16_f32 v44, v131, v143
 v_cvt_pk_bf16_f32 v60, v135, v147
 v_mul_f32 v200, v168, v112
 v_mul_f32 v201, v169, v113
 s_waitcnt lgkmcnt(1)
 v_mfma_f32_16x16x32_bf16 v[188:191], v[88:91], v[96:99], 0
 v_mul_f32 v202, v170, v114
 v_mul_f32 v203, v171, v115
 v_mul_f32 v204, v172, v116
 v_mul_f32 v205, v173, v117
 v_mul_f32 v206, v174, v118
 v_mul_f32 v207, v175, v119
 v_mfma_f32_16x16x32_bf16 v[196:199], v[88:91], v[104:107], 0
 v_mul_f32 v208, v176, v112
 v_mul_f32 v209, v177, v113
 v_mul_f32 v210, v178, v114
 v_mul_f32 v211, v179, v115
 v_mul_f32 v212, v180, v116
 v_mul_f32 v213, v181, v117
 v_mul_f32 v214, v182, v118
 v_mfma_f32_16x16x32_bf16 v[184:187], v[84:87], v[100:103], v[184:187]
 v_mul_f32 v215, v183, v119
 v_fmac_f32 v200, v176, v120
 v_fmac_f32 v201, v177, v121
 v_fmac_f32 v202, v178, v122
 v_fmac_f32 v203, v179, v123
 v_fmac_f32 v204, v180, v124
 v_mfma_f32_16x16x32_bf16 v[192:195], v[84:87], v[108:111], v[192:195]
 v_fmac_f32 v205, v181, v125
 v_fmac_f32 v206, v182, v126
 v_fmac_f32 v207, v183, v127
 v_fma_f32 v208, -v168, v120, v208
 v_fma_f32 v209, -v169, v121, v209
 v_fma_f32 v210, -v170, v122, v210
 s_waitcnt lgkmcnt(0)
 v_mfma_f32_16x16x32_bf16 v[188:191], v[92:95], v[100:103], v[188:191]
 v_fma_f32 v211, -v171, v123, v211
 v_fma_f32 v212, -v172, v124, v212
 v_fma_f32 v213, -v173, v125, v213
 v_fma_f32 v214, -v174, v126, v214
 v_fma_f32 v215, -v175, v127, v215
 v_cvt_pk_bf16_f32 v152, v200, v201
 v_mfma_f32_16x16x32_bf16 v[196:199], v[92:95], v[108:111], v[196:199]
 v_cvt_pk_bf16_f32 v153, v202, v203
 v_cvt_pk_bf16_f32 v154, v204, v205
 v_cvt_pk_bf16_f32 v155, v206, v207
 v_cvt_pk_bf16_f32 v156, v208, v209
 v_cvt_pk_bf16_f32 v157, v210, v211
 v_cvt_pk_bf16_f32 v158, v212, v213
 v_cvt_pk_bf16_f32 v159, v214, v215
 ds_read_b128 v[64:67], v7 offset:16384
 ds_read_b128 v[68:71], v7 offset:17408
 ds_read_b128 v[72:75], v7 offset:18432
 ds_read_b128 v[76:79], v7 offset:19456
 v_mfma_f32_16x16x32_bf16 v[128:131], v[216:219], v[152:155], 0
 v_mfma_f32_16x16x32_bf16 v[132:135], v[224:227], v[152:155], 0
 v_mfma_f32_16x16x32_bf16 v[136:139], v[232:235], v[152:155], 0
 v_mfma_f32_16x16x32_bf16 v[128:131], v[220:223], v[156:159], v[128:131]
 v_mfma_f32_16x16x32_bf16 v[132:135], v[216:219], v[156:159], v[132:135]
 s_waitcnt lgkmcnt(3)
 v_mfma_f32_16x16x32_bf16 v[168:171], v[64:67], v[96:99], 0
 v_mul_f32 v200, v184, v112
 v_mul_f32 v201, v185, v113
 v_mul_f32 v202, v186, v114
 v_mul_f32 v203, v187, v115
 v_mul_f32 v204, v188, v116
 v_mfma_f32_16x16x32_bf16 v[176:179], v[64:67], v[104:107], 0
 v_mul_f32 v205, v189, v117
 v_mul_f32 v206, v190, v118
 v_mul_f32 v207, v191, v119
 v_mul_f32 v208, v192, v112
 v_mul_f32 v209, v193, v113
 s_waitcnt lgkmcnt(1)
 v_mfma_f32_16x16x32_bf16 v[172:175], v[72:75], v[96:99], 0
 v_mul_f32 v210, v194, v114
 v_mul_f32 v211, v195, v115
 v_mul_f32 v212, v196, v116
 v_mul_f32 v213, v197, v117
 v_mul_f32 v214, v198, v118
 v_mfma_f32_16x16x32_bf16 v[180:183], v[72:75], v[104:107], 0
 v_mul_f32 v215, v199, v119
 v_fmac_f32 v200, v192, v120
 v_fmac_f32 v201, v193, v121
 v_fmac_f32 v202, v194, v122
 v_fmac_f32 v203, v195, v123
 v_mfma_f32_16x16x32_bf16 v[168:171], v[68:71], v[100:103], v[168:171]
 v_fmac_f32 v204, v196, v124
 v_fmac_f32 v205, v197, v125
 v_fmac_f32 v206, v198, v126
 v_fmac_f32 v207, v199, v127
 v_fma_f32 v208, -v184, v120, v208
 v_mfma_f32_16x16x32_bf16 v[176:179], v[68:71], v[108:111], v[176:179]
 v_fma_f32 v209, -v185, v121, v209
 v_fma_f32 v210, -v186, v122, v210
 v_fma_f32 v211, -v187, v123, v211
 v_fma_f32 v212, -v188, v124, v212
 v_fma_f32 v213, -v189, v125, v213
 s_waitcnt lgkmcnt(0)
 v_mfma_f32_16x16x32_bf16 v[172:175], v[76:79], v[100:103], v[172:175]
 v_fma_f32 v214, -v190, v126, v214
 v_fma_f32 v215, -v191, v127, v215
 v_cvt_pk_bf16_f32 v152, v200, v201
 v_cvt_pk_bf16_f32 v153, v202, v203
 v_cvt_pk_bf16_f32 v154, v204, v205
 v_mfma_f32_16x16x32_bf16 v[180:183], v[76:79], v[108:111], v[180:183]
 v_cvt_pk_bf16_f32 v155, v206, v207
 v_cvt_pk_bf16_f32 v156, v208, v209
 v_cvt_pk_bf16_f32 v157, v210, v211
 v_cvt_pk_bf16_f32 v158, v212, v213
 v_cvt_pk_bf16_f32 v159, v214, v215
 ds_read_b128 v[80:83], v7 offset:20480
 ds_read_b128 v[84:87], v7 offset:21504
 ds_read_b128 v[88:91], v7 offset:22528
 ds_read_b128 v[92:95], v7 offset:23552
 v_mfma_f32_16x16x32_bf16 v[140:143], v[216:219], v[152:155], 0
 v_mfma_f32_16x16x32_bf16 v[144:147], v[224:227], v[152:155], 0
 v_mfma_f32_16x16x32_bf16 v[148:151], v[232:235], v[152:155], 0
 v_mfma_f32_16x16x32_bf16 v[140:143], v[220:223], v[156:159], v[140:143]
 v_mfma_f32_16x16x32_bf16 v[144:147], v[216:219], v[156:159], v[144:147]
 s_waitcnt lgkmcnt(3)
 v_mfma_f32_16x16x32_bf16 v[184:187], v[80:83], v[96:99], 0
 v_cndmask_b32 v132, v132, v136, s[64:65]
 s_nop 4
 v_cndmask_b32 v144, v144, v148, s[64:65]
 v_cvt_pk_bf16_f32 v33, v128, v140
 v_cvt_pk_bf16_f32 v49, v132, v144
 v_cvt_pk_bf16_f32 v37, v129, v141
 v_cvt_pk_bf16_f32 v53, v133, v145
 v_mfma_f32_16x16x32_bf16 v[192:195], v[80:83], v[104:107], 0
 v_cvt_pk_bf16_f32 v41, v130, v142
 v_cvt_pk_bf16_f32 v57, v134, v146
 v_cvt_pk_bf16_f32 v45, v131, v143
 v_cvt_pk_bf16_f32 v61, v135, v147
 v_mul_f32 v200, v168, v112
 v_mul_f32 v201, v169, v113
 s_waitcnt lgkmcnt(1)
 v_mfma_f32_16x16x32_bf16 v[188:191], v[88:91], v[96:99], 0
 v_mul_f32 v202, v170, v114
 v_mul_f32 v203, v171, v115
 v_mul_f32 v204, v172, v116
 v_mul_f32 v205, v173, v117
 v_mul_f32 v206, v174, v118
 v_mul_f32 v207, v175, v119
 v_mfma_f32_16x16x32_bf16 v[196:199], v[88:91], v[104:107], 0
 v_mul_f32 v208, v176, v112
 v_mul_f32 v209, v177, v113
 v_mul_f32 v210, v178, v114
 v_mul_f32 v211, v179, v115
 v_mul_f32 v212, v180, v116
 v_mul_f32 v213, v181, v117
 v_mul_f32 v214, v182, v118
 v_mfma_f32_16x16x32_bf16 v[184:187], v[84:87], v[100:103], v[184:187]
 v_mul_f32 v215, v183, v119
 v_fmac_f32 v200, v176, v120
 v_fmac_f32 v201, v177, v121
 v_fmac_f32 v202, v178, v122
 v_fmac_f32 v203, v179, v123
 v_fmac_f32 v204, v180, v124
 v_mfma_f32_16x16x32_bf16 v[192:195], v[84:87], v[108:111], v[192:195]
 v_fmac_f32 v205, v181, v125
 v_fmac_f32 v206, v182, v126
 v_fmac_f32 v207, v183, v127
 v_fma_f32 v208, -v168, v120, v208
 v_fma_f32 v209, -v169, v121, v209
 v_fma_f32 v210, -v170, v122, v210
 s_waitcnt lgkmcnt(0)
 v_mfma_f32_16x16x32_bf16 v[188:191], v[92:95], v[100:103], v[188:191]
 v_fma_f32 v211, -v171, v123, v211
 v_fma_f32 v212, -v172, v124, v212
 v_fma_f32 v213, -v173, v125, v213
 v_fma_f32 v214, -v174, v126, v214
 v_fma_f32 v215, -v175, v127, v215
 v_cvt_pk_bf16_f32 v152, v200, v201
 v_mfma_f32_16x16x32_bf16 v[196:199], v[92:95], v[108:111], v[196:199]
 v_cvt_pk_bf16_f32 v153, v202, v203
 v_cvt_pk_bf16_f32 v154, v204, v205
 v_cvt_pk_bf16_f32 v155, v206, v207
 v_cvt_pk_bf16_f32 v156, v208, v209
 v_cvt_pk_bf16_f32 v157, v210, v211
 v_cvt_pk_bf16_f32 v158, v212, v213
 v_cvt_pk_bf16_f32 v159, v214, v215
 ds_read_b128 v[64:67], v7 offset:24576
 ds_read_b128 v[68:71], v7 offset:25600
 ds_read_b128 v[72:75], v7 offset:26624
 ds_read_b128 v[76:79], v7 offset:27648
 v_mfma_f32_16x16x32_bf16 v[128:131], v[216:219], v[152:155], 0
 v_mfma_f32_16x16x32_bf16 v[132:135], v[224:227], v[152:155], 0
 v_mfma_f32_16x16x32_bf16 v[136:139], v[232:235], v[152:155], 0
 v_mfma_f32_16x16x32_bf16 v[128:131], v[220:223], v[156:159], v[128:131]
 v_mfma_f32_16x16x32_bf16 v[132:135], v[216:219], v[156:159], v[132:135]
 s_waitcnt lgkmcnt(3)
 v_mfma_f32_16x16x32_bf16 v[168:171], v[64:67], v[96:99], 0
 v_mul_f32 v200, v184, v112
 v_mul_f32 v201, v185, v113
 v_mul_f32 v202, v186, v114
 v_mul_f32 v203, v187, v115
 v_mul_f32 v204, v188, v116
 v_mfma_f32_16x16x32_bf16 v[176:179], v[64:67], v[104:107], 0
 v_mul_f32 v205, v189, v117
 v_mul_f32 v206, v190, v118
 v_mul_f32 v207, v191, v119
 v_mul_f32 v208, v192, v112
 v_mul_f32 v209, v193, v113
 s_waitcnt lgkmcnt(1)
 v_mfma_f32_16x16x32_bf16 v[172:175], v[72:75], v[96:99], 0
 v_mul_f32 v210, v194, v114
 v_mul_f32 v211, v195, v115
 v_mul_f32 v212, v196, v116
 v_mul_f32 v213, v197, v117
 v_mul_f32 v214, v198, v118
 v_mfma_f32_16x16x32_bf16 v[180:183], v[72:75], v[104:107], 0
 v_mul_f32 v215, v199, v119
 v_fmac_f32 v200, v192, v120
 v_fmac_f32 v201, v193, v121
 v_fmac_f32 v202, v194, v122
 v_fmac_f32 v203, v195, v123
 v_mfma_f32_16x16x32_bf16 v[168:171], v[68:71], v[100:103], v[168:171]
 v_fmac_f32 v204, v196, v124
 v_fmac_f32 v205, v197, v125
 v_fmac_f32 v206, v198, v126
 v_fmac_f32 v207, v199, v127
 v_fma_f32 v208, -v184, v120, v208
 v_mfma_f32_16x16x32_bf16 v[176:179], v[68:71], v[108:111], v[176:179]
 v_fma_f32 v209, -v185, v121, v209
 v_fma_f32 v210, -v186, v122, v210
 v_fma_f32 v211, -v187, v123, v211
 v_fma_f32 v212, -v188, v124, v212
 v_fma_f32 v213, -v189, v125, v213
 s_waitcnt lgkmcnt(0)
 v_mfma_f32_16x16x32_bf16 v[172:175], v[76:79], v[100:103], v[172:175]
 v_fma_f32 v214, -v190, v126, v214
 v_fma_f32 v215, -v191, v127, v215
 v_cvt_pk_bf16_f32 v152, v200, v201
 v_cvt_pk_bf16_f32 v153, v202, v203
 v_cvt_pk_bf16_f32 v154, v204, v205
 v_mfma_f32_16x16x32_bf16 v[180:183], v[76:79], v[108:111], v[180:183]
 v_cvt_pk_bf16_f32 v155, v206, v207
 v_cvt_pk_bf16_f32 v156, v208, v209
 v_cvt_pk_bf16_f32 v157, v210, v211
 v_cvt_pk_bf16_f32 v158, v212, v213
 v_cvt_pk_bf16_f32 v159, v214, v215
 ds_read_b128 v[80:83], v7 offset:28672
 ds_read_b128 v[84:87], v7 offset:29696
 ds_read_b128 v[88:91], v7 offset:30720
 ds_read_b128 v[92:95], v7 offset:31744
 v_mfma_f32_16x16x32_bf16 v[140:143], v[216:219], v[152:155], 0
 v_mfma_f32_16x16x32_bf16 v[144:147], v[224:227], v[152:155], 0
 v_mfma_f32_16x16x32_bf16 v[148:151], v[232:235], v[152:155], 0
 v_mfma_f32_16x16x32_bf16 v[140:143], v[220:223], v[156:159], v[140:143]
 v_mfma_f32_16x16x32_bf16 v[144:147], v[216:219], v[156:159], v[144:147]
 s_waitcnt lgkmcnt(3)
 v_mfma_f32_16x16x32_bf16 v[184:187], v[80:83], v[96:99], 0
 v_cndmask_b32 v132, v132, v136, s[64:65]
 s_nop 4
 v_cndmask_b32 v144, v144, v148, s[64:65]
 v_cvt_pk_bf16_f32 v34, v128, v140
 v_cvt_pk_bf16_f32 v50, v132, v144
 v_cvt_pk_bf16_f32 v38, v129, v141
 v_cvt_pk_bf16_f32 v54, v133, v145
 v_mfma_f32_16x16x32_bf16 v[192:195], v[80:83], v[104:107], 0
 v_cvt_pk_bf16_f32 v42, v130, v142
 v_cvt_pk_bf16_f32 v58, v134, v146
 v_cvt_pk_bf16_f32 v46, v131, v143
 v_cvt_pk_bf16_f32 v62, v135, v147
 v_mul_f32 v200, v168, v112
 v_mul_f32 v201, v169, v113
 s_waitcnt lgkmcnt(1)
 v_mfma_f32_16x16x32_bf16 v[188:191], v[88:91], v[96:99], 0
 v_mul_f32 v202, v170, v114
 v_mul_f32 v203, v171, v115
 v_mul_f32 v204, v172, v116
 v_mul_f32 v205, v173, v117
 v_mul_f32 v206, v174, v118
 v_mul_f32 v207, v175, v119
 v_mfma_f32_16x16x32_bf16 v[196:199], v[88:91], v[104:107], 0
 v_mul_f32 v208, v176, v112
 v_mul_f32 v209, v177, v113
 v_mul_f32 v210, v178, v114
 v_mul_f32 v211, v179, v115
 v_mul_f32 v212, v180, v116
 v_mul_f32 v213, v181, v117
 v_mul_f32 v214, v182, v118
 v_mfma_f32_16x16x32_bf16 v[184:187], v[84:87], v[100:103], v[184:187]
 v_mul_f32 v215, v183, v119
 v_fmac_f32 v200, v176, v120
 v_fmac_f32 v201, v177, v121
 v_fmac_f32 v202, v178, v122
 v_fmac_f32 v203, v179, v123
 v_fmac_f32 v204, v180, v124
 v_mfma_f32_16x16x32_bf16 v[192:195], v[84:87], v[108:111], v[192:195]
 v_fmac_f32 v205, v181, v125
 v_fmac_f32 v206, v182, v126
 v_fmac_f32 v207, v183, v127
 v_fma_f32 v208, -v168, v120, v208
 v_fma_f32 v209, -v169, v121, v209
 v_fma_f32 v210, -v170, v122, v210
 s_waitcnt lgkmcnt(0)
 v_mfma_f32_16x16x32_bf16 v[188:191], v[92:95], v[100:103], v[188:191]
 v_fma_f32 v211, -v171, v123, v211
 v_fma_f32 v212, -v172, v124, v212
 v_fma_f32 v213, -v173, v125, v213
 v_fma_f32 v214, -v174, v126, v214
 v_fma_f32 v215, -v175, v127, v215
 v_cvt_pk_bf16_f32 v152, v200, v201
 v_mfma_f32_16x16x32_bf16 v[196:199], v[92:95], v[108:111], v[196:199]
 v_cvt_pk_bf16_f32 v153, v202, v203
 v_cvt_pk_bf16_f32 v154, v204, v205
 v_cvt_pk_bf16_f32 v155, v206, v207
 v_cvt_pk_bf16_f32 v156, v208, v209
 v_cvt_pk_bf16_f32 v157, v210, v211
 v_cvt_pk_bf16_f32 v158, v212, v213
 v_cvt_pk_bf16_f32 v159, v214, v215
 v_mfma_f32_16x16x32_bf16 v[128:131], v[216:219], v[152:155], 0
 v_mfma_f32_16x16x32_bf16 v[132:135], v[224:227], v[152:155], 0
 v_mfma_f32_16x16x32_bf16 v[136:139], v[232:235], v[152:155], 0
 v_mfma_f32_16x16x32_bf16 v[128:131], v[220:223], v[156:159], v[128:131]
 v_mfma_f32_16x16x32_bf16 v[132:135], v[216:219], v[156:159], v[132:135]
 v_mul_f32 v200, v184, v112
 v_mul_f32 v201, v185, v113
 v_mul_f32 v202, v186, v114
 v_mul_f32 v203, v187, v115
 v_mul_f32 v204, v188, v116
 v_mul_f32 v205, v189, v117
 v_mul_f32 v206, v190, v118
 v_mul_f32 v207, v191, v119
 v_mul_f32 v208, v192, v112
 v_mul_f32 v209, v193, v113
 v_mul_f32 v210, v194, v114
 v_mul_f32 v211, v195, v115
 v_mul_f32 v212, v196, v116
 v_mul_f32 v213, v197, v117
 v_mul_f32 v214, v198, v118
 v_mul_f32 v215, v199, v119
 v_fmac_f32 v200, v192, v120
 v_fmac_f32 v201, v193, v121
 v_fmac_f32 v202, v194, v122
 v_fmac_f32 v203, v195, v123
 v_fmac_f32 v204, v196, v124
 v_fmac_f32 v205, v197, v125
 v_fmac_f32 v206, v198, v126
 v_fmac_f32 v207, v199, v127
 v_fma_f32 v208, -v184, v120, v208
 v_fma_f32 v209, -v185, v121, v209
 v_fma_f32 v210, -v186, v122, v210
 v_fma_f32 v211, -v187, v123, v211
 v_fma_f32 v212, -v188, v124, v212
 v_fma_f32 v213, -v189, v125, v213
 v_fma_f32 v214, -v190, v126, v214
 v_fma_f32 v215, -v191, v127, v215
 v_cvt_pk_bf16_f32 v152, v200, v201
 v_cvt_pk_bf16_f32 v153, v202, v203
 v_cvt_pk_bf16_f32 v154, v204, v205
 v_cvt_pk_bf16_f32 v155, v206, v207
 v_cvt_pk_bf16_f32 v156, v208, v209
 v_cvt_pk_bf16_f32 v157, v210, v211
 v_cvt_pk_bf16_f32 v158, v212, v213
 v_cvt_pk_bf16_f32 v159, v214, v215
 v_mfma_f32_16x16x32_bf16 v[140:143], v[216:219], v[152:155], 0
 v_mfma_f32_16x16x32_bf16 v[144:147], v[224:227], v[152:155], 0
 v_mfma_f32_16x16x32_bf16 v[148:151], v[232:235], v[152:155], 0
 v_mfma_f32_16x16x32_bf16 v[140:143], v[220:223], v[156:159], v[140:143]
 v_mfma_f32_16x16x32_bf16 v[144:147], v[216:219], v[156:159], v[144:147]
 v_cndmask_b32 v132, v132, v136, s[64:65]
 s_nop 6
 v_cndmask_b32 v144, v144, v148, s[64:65]
 v_cvt_pk_bf16_f32 v35, v128, v140
 v_cvt_pk_bf16_f32 v51, v132, v144
 v_cvt_pk_bf16_f32 v39, v129, v141
 v_cvt_pk_bf16_f32 v55, v133, v145
 v_cvt_pk_bf16_f32 v43, v130, v142
 v_cvt_pk_bf16_f32 v59, v134, v146
 v_cvt_pk_bf16_f32 v47, v131, v143
 v_cvt_pk_bf16_f32 v63, v135, v147
 buffer_store_dwordx4 v[32:35], v8, s[52:55], s38 offen sc1
 buffer_store_dwordx4 v[48:51], v8, s[52:55], s38 offen offset:1024 sc1
 s_add_u32 s38, s38, 0x20000
 buffer_store_dwordx4 v[36:39], v8, s[52:55], s38 offen sc1
 buffer_store_dwordx4 v[52:55], v8, s[52:55], s38 offen offset:1024 sc1
 s_add_u32 s38, s38, 0x20000
 buffer_store_dwordx4 v[40:43], v8, s[52:55], s38 offen sc1
 buffer_store_dwordx4 v[56:59], v8, s[52:55], s38 offen offset:1024 sc1
 s_add_u32 s38, s38, 0x20000
 buffer_store_dwordx4 v[44:47], v8, s[52:55], s38 offen sc1
 buffer_store_dwordx4 v[60:63], v8, s[52:55], s38 offen offset:1024 sc1
 s_cmp_eq_u32 s29, 0
 s_cbranch_scc1 K1_XE
K1_XDONE:
 s_endpgm
K1_XE:
 s_cmp_eq_u32 s39, 0
 s_cbranch_scc1 K1_XE2
 s_waitcnt vmcnt(0)
 s_movk_i32 s82, 0xff
 s_mov_b32 s83, 0
K1_EP:
 s_nop 0
 s_bitcmp1_b32 s82, 0
 s_cbranch_scc0 K1_EP0
 buffer_load_dwordx4 v[32:35], v5, s[68:71], s78 offen offset:0 sc1
K1_EP0:
 s_bitcmp1_b32 s82, 1
 s_cbranch_scc0 K1_EP1
 buffer_load_dwordx4 v[36:39], v5, s[68:71], s78 offen offset:512 sc1
K1_EP1:
 s_bitcmp1_b32 s82, 2
 s_cbranch_scc0 K1_EP2
 buffer_load_dwordx4 v[40:43], v5, s[68:71], s78 offen offset:1024 sc1
K1_EP2:
 s_bitcmp1_b32 s82, 3
 s_cbranch_scc0 K1_EP3
 buffer_load_dwordx4 v[44:47], v5, s[68:71], s78 offen offset:1536 sc1
K1_EP3:
 s_bitcmp1_b32 s82, 4
 s_cbranch_scc0 K1_EP4
 buffer_load_dwordx4 v[48:51], v5, s[68:71], s78 offen offset:2048 sc1
K1_EP4:
 s_bitcmp1_b32 s82, 5
 s_cbranch_scc0 K1_EP5
 buffer_load_dwordx4 v[52:55], v5, s[68:71], s78 offen offset:2560 sc1
K1_EP5:
 s_bitcmp1_b32 s82, 6
 s_cbranch_scc0 K1_EP6
 buffer_load_dwordx4 v[56:59], v5, s[68:71], s78 offen offset:3072 sc1
K1_EP6:
 s_bitcmp1_b32 s82, 7
 s_cbranch_scc0 K1_EP7
 buffer_load_dwordx4 v[60:63], v5, s[68:71], s78 offen offset:3584 sc1
K1_EP7:
 s_waitcnt vmcnt(0)
 s_mov_b32 s82, 0
 v_cmp_ne_u64 vcc, s[66:67], v[34:35]
 s_nop 0
 s_cmp_lg_u64 vcc, 0
 s_cselect_b32 s3, 1, 0
 s_or_b32 s82, s82, s3
 v_cmp_ne_u64 vcc, s[66:67], v[38:39]
 s_nop 0
 s_cmp_lg_u64 vcc, 0
 s_cselect_b32 s3, 2, 0
 s_or_b32 s82, s82, s3
 v_cmp_ne_u64 vcc, s[66:67], v[42:43]
 s_nop 0
 s_cmp_lg_u64 vcc, 0
 s_cselect_b32 s3, 4, 0
 s_or_b32 s82, s82, s3
 v_cmp_ne_u64 vcc, s[66:67], v[46:47]
 s_nop 0
 s_cmp_lg_u64 vcc, 0
 s_cselect_b32 s3, 8, 0
 s_or_b32 s82, s82, s3
 v_cmp_ne_u64 vcc, s[66:67], v[50:51]
 s_nop 0
 s_cmp_lg_u64 vcc, 0
 s_cselect_b32 s3, 16, 0
 s_or_b32 s82, s82, s3
 v_cmp_ne_u64 vcc, s[66:67], v[54:55]
 s_nop 0
 s_cmp_lg_u64 vcc, 0
 s_cselect_b32 s3, 32, 0
 s_or_b32 s82, s82, s3
 v_cmp_ne_u64 vcc, s[66:67], v[58:59]
 s_nop 0
 s_cmp_lg_u64 vcc, 0
 s_cselect_b32 s3, 64, 0
 s_or_b32 s82, s82, s3
 v_cmp_ne_u64 vcc, s[66:67], v[62:63]
 s_nop 0
 s_cmp_lg_u64 vcc, 0
 s_cselect_b32 s3, 128, 0
 s_or_b32 s82, s82, s3
 s_cbranch_scc0 K1_XE2
 s_add_u32 s83, s83, 1
 s_sleep 8
 s_branch K1_EP
K1_XE2:
 s_barrier
 v_mov_b32 v2, s66
 v_mov_b32 v3, s67
 buffer_store_dwordx2 v[2:3], v24, s[68:71], 0 offen offset:0 sc1
 s_branch K1_XDONE
K1_XSLOW:
 s_mov_b32 s39, 1
 s_lshl_b32 s76, s20, 18
 s_lshl_b32 s3, s20, 12
 s_add_u32 s3, s3, 69632
 v_lshrrev_b32 v13, 5, v1
 v_lshlrev_b32 v13, 4, v13
 v_add_u32 v13, s3, v13
 v_add_u32 v12, s3, v5
 s_mov_b32 s84, 0
 v_mov_b32 v32, v128
 v_mov_b32 v33, v129
 v_mov_b32 v34, v130
 v_mov_b32 v35, v131
 v_mov_b32 v36, v132
 v_mov_b32 v37, v133
 v_mov_b32 v38, v134
 v_mov_b32 v39, v135
 v_mov_b32 v40, v136
 v_mov_b32 v41, v137
 v_mov_b32 v42, v138
 v_mov_b32 v43, v139
 v_mov_b32 v44, v140
 v_mov_b32 v45, v141
 v_mov_b32 v46, v142
 v_mov_b32 v47, v143
 v_mov_b32 v48, v144
 v_mov_b32 v49, v145
 v_mov_b32 v50, v146
 v_mov_b32 v51, v147
 v_mov_b32 v52, v148
 v_mov_b32 v53, v149
 v_mov_b32 v54, v150
 v_mov_b32 v55, v151
 v_mov_b32 v56, v152
 v_mov_b32 v57, v153
 v_mov_b32 v58, v154
 v_mov_b32 v59, v155
 v_mov_b32 v60, v156
 v_mov_b32 v61, v157
 v_mov_b32 v62, v158
 v_mov_b32 v63, v159
 v_mov_b32 v64, v160
 v_mov_b32 v65, v161
 v_mov_b32 v66, v162
 v_mov_b32 v67, v163
 v_mov_b32 v68, v164
 v_mov_b32 v69, v165
 v_mov_b32 v70, v166
 v_mov_b32 v71, v167
K1_XSLOW_R:
 buffer_load_dwordx4 v[128:131], v25, s[44:47], s76 offen
 buffer_load_dwordx4 v[132:135], v25, s[44:47], s76 offen offset:1024
 s_waitcnt vmcnt(0)
 v_lshlrev_b32 v136, 16, v128
 v_and_b32 v137, s40, v128
 v_lshlrev_b32 v138, 16, v129
 v_and_b32 v139, s40, v129
 v_lshlrev_b32 v140, 16, v130
 v_and_b32 v141, s40, v130
 v_lshlrev_b32 v142, 16, v131
 v_and_b32 v143, s40, v131
 v_add_f32 v146, v136, v137
 v_mul_f32 v147, v136, v136
 v_fmac_f32 v147, v137, v137
 v_fmac_f32 v147, v138, v138
 v_fmac_f32 v147, v139, v139
 v_fmac_f32 v147, v140, v140
 v_fmac_f32 v147, v141, v141
 v_fmac_f32 v147, v142, v142
 v_fmac_f32 v147, v143, v143
 v_add_f32 v146, v146, v138
 v_add_f32 v146, v146, v139
 v_add_f32 v146, v146, v140
 v_add_f32 v146, v146, v141
 v_add_f32 v146, v146, v142
 v_add_f32 v146, v146, v143
 v_lshlrev_b32 v136, 16, v132
 v_and_b32 v137, s40, v132
 v_lshlrev_b32 v138, 16, v133
 v_and_b32 v139, s40, v133
 v_lshlrev_b32 v140, 16, v134
 v_and_b32 v141, s40, v134
 v_lshlrev_b32 v142, 16, v135
 v_and_b32 v143, s40, v135
 v_add_f32 v148, v136, v137
 v_mul_f32 v149, v136, v136
 v_fmac_f32 v149, v137, v137
 v_fmac_f32 v149, v138, v138
 v_fmac_f32 v149, v139, v139
 v_fmac_f32 v149, v140, v140
 v_fmac_f32 v149, v141, v141
 v_fmac_f32 v149, v142, v142
 v_fmac_f32 v149, v143, v143
 v_add_f32 v148, v148, v138
 v_add_f32 v148, v148, v139
 v_add_f32 v148, v148, v140
 v_add_f32 v148, v148, v141
 v_add_f32 v148, v148, v142
 v_add_f32 v148, v148, v143
 s_nop 1
 v_permlane32_swap_b32 v146, v148
 v_permlane32_swap_b32 v147, v149
 v_add_f32 v146, v146, v148
 v_add_f32 v147, v147, v149
 v_mov_b32 v148, v146
 v_mov_b32 v149, v147
 s_nop 0
 v_permlane16_swap_b32 v146, v148
 v_permlane16_swap_b32 v147, v149
 v_add_f32 v146, v146, v148
 v_add_f32 v147, v147, v149
 s_nop 0
 v_add_f32_dpp v146, v146, v146 row_ror:8 row_mask:0xf bank_mask:0xf
 v_add_f32_dpp v147, v147, v147 row_ror:8 row_mask:0xf bank_mask:0xf
 s_nop 0
 v_add_f32_dpp v146, v146, v146 row_ror:4 row_mask:0xf bank_mask:0xf
 v_add_f32_dpp v147, v147, v147 row_ror:4 row_mask:0xf bank_mask:0xf
 s_nop 0
 v_add_f32_dpp v146, v146, v146 row_ror:2 row_mask:0xf bank_mask:0xf
 v_add_f32_dpp v147, v147, v147 row_ror:2 row_mask:0xf bank_mask:0xf
 s_nop 0
 v_add_f32_dpp v146, v146, v146 row_ror:1 row_mask:0xf bank_mask:0xf
 v_add_f32_dpp v147, v147, v147 row_ror:1 row_mask:0xf bank_mask:0xf
 v_mul_f32 v164, 0x3b000000, v146
 v_mul_f32 v166, 0x3b000000, v147
 v_fma_f32 v166, -v164, v164, v166
 v_max_f32 v166, 0, v166
 v_cvt_pk_bf16_f32 v167, v164, v166
 v_lshlrev_b32 v164, 16, v167
 v_and_b32 v166, s40, v167
 v_add_f32 v166, 0x3727c5ac, v166
 v_cvt_pk_bf16_f32 v166, v166, v166
 v_and_b32 v166, s40, v166
 v_sqrt_f32 v166, v166
 s_nop 0
 v_cvt_pk_bf16_f32 v166, v166, v166
 v_and_b32 v166, s40, v166
 v_rcp_f32 v165, v166
 s_nop 0
 v_mul_f32 v166, v164, v165
 ds_write_b128 v13, v[164:167]
 v_add_u32 v13, 32, v13
 s_add_u32 s76, s76, 2048
 s_add_u32 s84, s84, 1
 s_cmp_lt_u32 s84, 128
 s_cbranch_scc1 K1_XSLOW_R
 s_waitcnt lgkmcnt(0)
 v_mov_b32 v128, v32
 v_mov_b32 v129, v33
 v_mov_b32 v130, v34
 v_mov_b32 v131, v35
 v_mov_b32 v132, v36
 v_mov_b32 v133, v37
 v_mov_b32 v134, v38
 v_mov_b32 v135, v39
 v_mov_b32 v136, v40
 v_mov_b32 v137, v41
 v_mov_b32 v138, v42
 v_mov_b32 v139, v43
 v_mov_b32 v140, v44
 v_mov_b32 v141, v45
 v_mov_b32 v142, v46
 v_mov_b32 v143, v47
 v_mov_b32 v144, v48
 v_mov_b32 v145, v49
 v_mov_b32 v146, v50
 v_mov_b32 v147, v51
 v_mov_b32 v148, v52
 v_mov_b32 v149, v53
 v_mov_b32 v150, v54
 v_mov_b32 v151, v55
 v_mov_b32 v152, v56
 v_mov_b32 v153, v57
 v_mov_b32 v154, v58
 v_mov_b32 v155, v59
 v_mov_b32 v156, v60
 v_mov_b32 v157, v61
 v_mov_b32 v158, v62
 v_mov_b32 v159, v63
 v_mov_b32 v160, v64
 v_mov_b32 v161, v65
 v_mov_b32 v162, v66
 v_mov_b32 v163, v67
 v_mov_b32 v164, v68
 v_mov_b32 v165, v69
 v_mov_b32 v166, v70
 v_mov_b32 v167, v71
 ds_read_b64 v[32:33], v12 offset:0
 ds_read_b64 v[36:37], v12 offset:512
 ds_read_b64 v[40:41], v12 offset:1024
 ds_read_b64 v[44:45], v12 offset:1536
 ds_read_b64 v[48:49], v12 offset:2048
 ds_read_b64 v[52:53], v12 offset:2560
 ds_read_b64 v[56:57], v12 offset:3072
 ds_read_b64 v[60:61], v12 offset:3584
 s_waitcnt lgkmcnt(0)
 s_branch K1_XBACK
K1_END:
 s_endpgm
.globl fnet_g2_kernel
.p2align 8
.type fnet_g2_kernel,@function
fnet_g2_kernel:
 s_cmp_ge_u32 s2, 256
 s_cbranch_scc1 K2_END
 s_load_dwordx2 s[18:19], s[0:1], 88
 s_load_dwordx2 s[4:5], s[0:1], 0
 s_load_dwordx2 s[6:7], s[0:1], 72
 v_lshrrev_b32 v2, 6, v0
 v_and_b32 v1, 63, v0
 v_lshlrev_b32 v3, 4, v1
 v_readfirstlane_b32 s20, v2
 s_and_b32 s21, s2, 7
 s_lshr_b32 s22, s2, 3
 s_lshl_b32 s23, s21, 2
 s_lshr_b32 s3, s22, 3
 s_add_u32 s23, s23, s3
 s_and_b32 s24, s22, 7
 s_cmp_ge_u32 s20, 4
 s_cbranch_scc1 K2_S
 s_mul_i32 s3, s20, 28
 s_mul_i32 s25, s23, 112
 s_add_u32 s25, s25, s3
 s_lshl_b32 s25, s25, 11
 s_mul_i32 s26, s24, 112
 s_add_u32 s26, s26, s3
 s_lshl_b32 s26, s26, 11
 s_mov_b32 s46, 7340032
 s_mov_b32 s47, 0x20000
 s_mov_b32 s50, 1835008
 s_mov_b32 s51, 0x20000
 s_waitcnt lgkmcnt(0)
 s_mov_b32 s44, s18
 s_mov_b32 s45, s19
 s_add_u32 s48, s18, 8388608
 s_addc_u32 s49, s19, 0
 buffer_load_dwordx4 v[80:83], v3, s[48:51], s26 offen offset:0
 buffer_load_dwordx4 v[88:91], v3, s[44:47], s25 offen offset:0
 buffer_load_dwordx4 v[84:87], v3, s[48:51], s26 offen offset:1024
 buffer_load_dwordx4 v[92:95], v3, s[44:47], s25 offen offset:1024
 buffer_load_dwordx4 v[96:99], v3, s[48:51], s26 offen offset:2048
 buffer_load_dwordx4 v[104:107], v3, s[44:47], s25 offen offset:2048
 buffer_load_dwordx4 v[100:103], v3, s[48:51], s26 offen offset:3072
 buffer_load_dwordx4 v[108:111], v3, s[44:47], s25 offen offset:3072
 s_add_u32 s25, s25, 4096
 s_add_u32 s26, s26, 4096
 buffer_load_dwordx4 v[112:115], v3, s[48:51], s26 offen offset:0
 buffer_load_dwordx4 v[120:123], v3, s[44:47], s25 offen offset:0
 buffer_load_dwordx4 v[116:119], v3, s[48:51], s26 offen offset:1024
 buffer_load_dwordx4 v[124:127], v3, s[44:47], s25 offen offset:1024
 buffer_load_dwordx4 v[128:131], v3, s[48:51], s26 offen offset:2048
 buffer_load_dwordx4 v[136:139], v3, s[44:47], s25 offen offset:2048
 buffer_load_dwordx4 v[132:135], v3, s[48:51], s26 offen offset:3072
 buffer_load_dwordx4 v[140:143], v3, s[44:47], s25 offen offset:3072
 s_add_u32 s25, s25, 4096
 s_add_u32 s26, s26, 4096
 buffer_load_dwordx4 v[144:147], v3, s[48:51], s26 offen offset:0
 buffer_load_dwordx4 v[152:155], v3, s[44:47], s25 offen offset:0
 buffer_load_dwordx4 v[148:151], v3, s[48:51], s26 offen offset:1024
 buffer_load_dwordx4 v[156:159], v3, s[44:47], s25 offen offset:1024
 buffer_load_dwordx4 v[160:163], v3, s[48:51], s26 offen offset:2048
 buffer_load_dwordx4 v[168:171], v3, s[44:47], s25 offen offset:2048
 buffer_load_dwordx4 v[164:167], v3, s[48:51], s26 offen offset:3072
 buffer_load_dwordx4 v[172:175], v3, s[44:47], s25 offen offset:3072
 s_add_u32 s25, s25, 4096
 s_add_u32 s26, s26, 4096
 buffer_load_dwordx4 v[176:179], v3, s[48:51], s26 offen offset:0
 buffer_load_dwordx4 v[184:187], v3, s[44:47], s25 offen offset:0
 buffer_load_dwordx4 v[180:183], v3, s[48:51], s26 offen offset:1024
 buffer_load_dwordx4 v[188:191], v3, s[44:47], s25 offen offset:1024
 buffer_load_dwordx4 v[192:195], v3, s[48:51], s26 offen offset:2048
 buffer_load_dwordx4 v[200:203], v3, s[44:47], s25 offen offset:2048
 buffer_load_dwordx4 v[196:199], v3, s[48:51], s26 offen offset:3072
 buffer_load_dwordx4 v[204:207], v3, s[44:47], s25 offen offset:3072
 v_and_b32 v15, 31, v1
 v_lshrrev_b32 v16, 5, v1
 v_mul_u32_u24 v5, 272, v15
 v_lshl_add_u32 v5, v16, 4, v5
 s_mul_i32 s35, s20, 17408
 v_add_u32 v5, s35, v5
 s_waitcnt vmcnt(28)
 v_mfma_f32_32x32x16_bf16 v[16:31], v[80:83], v[88:91], 0
 s_add_u32 s25, s25, 4096
 s_add_u32 s26, s26, 4096
 buffer_load_dwordx4 v[208:211], v3, s[48:51], s26 offen offset:0
 buffer_load_dwordx4 v[216:219], v3, s[44:47], s25 offen offset:0
 v_mfma_f32_32x32x16_bf16 v[32:47], v[80:83], v[92:95], 0
 buffer_load_dwordx4 v[212:215], v3, s[48:51], s26 offen offset:1024
 buffer_load_dwordx4 v[220:223], v3, s[44:47], s25 offen offset:1024
 v_mfma_f32_32x32x16_bf16 v[48:63], v[84:87], v[88:91], 0
 v_mfma_f32_32x32x16_bf16 v[64:79], v[84:87], v[92:95], 0
 s_waitcnt vmcnt(28)
 v_mfma_f32_32x32x16_bf16 v[16:31], v[96:99], v[104:107], v[16:31]
 buffer_load_dwordx4 v[224:227], v3, s[48:51], s26 offen offset:2048
 buffer_load_dwordx4 v[232:235], v3, s[44:47], s25 offen offset:2048
 v_mfma_f32_32x32x16_bf16 v[32:47], v[96:99], v[108:111], v[32:47]
 buffer_load_dwordx4 v[228:231], v3, s[48:51], s26 offen offset:3072
 buffer_load_dwordx4 v[236:239], v3, s[44:47], s25 offen offset:3072
 v_mfma_f32_32x32x16_bf16 v[48:63], v[100:103], v[104:107], v[48:63]
 v_mfma_f32_32x32x16_bf16 v[64:79], v[100:103], v[108:111], v[64:79]
 s_waitcnt vmcnt(28)
 v_mfma_f32_32x32x16_bf16 v[16:31], v[112:115], v[120:123], v[16:31]
 s_add_u32 s25, s25, 4096
 s_add_u32 s26, s26, 4096
 buffer_load_dwordx4 v[240:243], v3, s[48:51], s26 offen offset:0
 buffer_load_dwordx4 v[248:251], v3, s[44:47], s25 offen offset:0
 v_mfma_f32_32x32x16_bf16 v[32:47], v[112:115], v[124:127], v[32:47]
 buffer_load_dwordx4 v[244:247], v3, s[48:51], s26 offen offset:1024
 buffer_load_dwordx4 v[252:255], v3, s[44:47], s25 offen offset:1024
 v_mfma_f32_32x32x16_bf16 v[48:63], v[116:119], v[120:123], v[48:63]
 v_mfma_f32_32x32x16_bf16 v[64:79], v[116:119], v[124:127], v[64:79]
 s_waitcnt vmcnt(28)
 v_mfma_f32_32x32x16_bf16 v[16:31], v[128:131], v[136:139], v[16:31]
 buffer_load_dwordx4 v[80:83], v3, s[48:51], s26 offen offset:2048
 buffer_load_dwordx4 v[88:91], v3, s[44:47], s25 offen offset:2048
 v_mfma_f32_32x32x16_bf16 v[32:47], v[128:131], v[140:143], v[32:47]
 buffer_load_dwordx4 v[84:87], v3, s[48:51], s26 offen offset:3072
 buffer_load_dwordx4 v[92:95], v3, s[44:47], s25 offen offset:3072
 v_mfma_f32_32x32x16_bf16 v[48:63], v[132:135], v[136:139], v[48:63]
 v_mfma_f32_32x32x16_bf16 v[64:79], v[132:135], v[140:143], v[64:79]
 s_waitcnt vmcnt(28)
 v_mfma_f32_32x32x16_bf16 v[16:31], v[144:147], v[152:155], v[16:31]
 s_add_u32 s25, s25, 4096
 s_add_u32 s26, s26, 4096
 buffer_load_dwordx4 v[96:99], v3, s[48:51], s26 offen offset:0
 buffer_load_dwordx4 v[104:107], v3, s[44:47], s25 offen offset:0
 v_mfma_f32_32x32x16_bf16 v[32:47], v[144:147], v[156:159], v[32:47]
 buffer_load_dwordx4 v[100:103], v3, s[48:51], s26 offen offset:1024
 buffer_load_dwordx4 v[108:111], v3, s[44:47], s25 offen offset:1024
 v_mfma_f32_32x32x16_bf16 v[48:63], v[148:151], v[152:155], v[48:63]
 v_mfma_f32_32x32x16_bf16 v[64:79], v[148:151], v[156:159], v[64:79]
 s_waitcnt vmcnt(28)
 v_mfma_f32_32x32x16_bf16 v[16:31], v[160:163], v[168:171], v[16:31]
 buffer_load_dwordx4 v[112:115], v3, s[48:51], s26 offen offset:2048
 buffer_load_dwordx4 v[120:123], v3, s[44:47], s25 offen offset:2048
 v_mfma_f32_32x32x16_bf16 v[32:47], v[160:163], v[172:175], v[32:47]
 buffer_load_dwordx4 v[116:119], v3, s[48:51], s26 offen offset:3072
 buffer_load_dwordx4 v[124:127], v3, s[44:47], s25 offen offset:3072
 v_mfma_f32_32x32x16_bf16 v[48:63], v[164:167], v[168:171], v[48:63]
 v_mfma_f32_32x32x16_bf16 v[64:79], v[164:167], v[172:175], v[64:79]
 s_waitcnt vmcnt(28)
 v_mfma_f32_32x32x16_bf16 v[16:31], v[176:179], v[184:187], v[16:31]
 s_add_u32 s25, s25, 4096
 s_add_u32 s26, s26, 4096
 buffer_load_dwordx4 v[128:131], v3, s[48:51], s26 offen offset:0
 buffer_load_dwordx4 v[136:139], v3, s[44:47], s25 offen offset:0
 v_mfma_f32_32x32x16_bf16 v[32:47], v[176:179], v[188:191], v[32:47]
 buffer_load_dwordx4 v[132:135], v3, s[48:51], s26 offen offset:1024
 buffer_load_dwordx4 v[140:143], v3, s[44:47], s25 offen offset:1024
 v_mfma_f32_32x32x16_bf16 v[48:63], v[180:183], v[184:187], v[48:63]
 v_mfma_f32_32x32x16_bf16 v[64:79], v[180:183], v[188:191], v[64:79]
 s_waitcnt vmcnt(28)
 v_mfma_f32_32x32x16_bf16 v[16:31], v[192:195], v[200:203], v[16:31]
 buffer_load_dwordx4 v[144:147], v3, s[48:51], s26 offen offset:2048
 buffer_load_dwordx4 v[152:155], v3, s[44:47], s25 offen offset:2048
 v_mfma_f32_32x32x16_bf16 v[32:47], v[192:195], v[204:207], v[32:47]
 buffer_load_dwordx4 v[148:151], v3, s[48:51], s26 offen offset:3072
 buffer_load_dwordx4 v[156:159], v3, s[44:47], s25 offen offset:3072
 v_mfma_f32_32x32x16_bf16 v[48:63], v[196:199], v[200:203], v[48:63]
 v_mfma_f32_32x32x16_bf16 v[64:79], v[196:199], v[204:207], v[64:79]
 s_waitcnt vmcnt(28)
 v_mfma_f32_32x32x16_bf16 v[16:31], v[208:211], v[216:219], v[16:31]
 s_add_u32 s25, s25, 4096
 s_add_u32 s26, s26, 4096
 buffer_load_dwordx4 v[160:163], v3, s[48:51], s26 offen offset:0
 buffer_load_dwordx4 v[168:171], v3, s[44:47], s25 offen offset:0
 v_mfma_f32_32x32x16_bf16 v[32:47], v[208:211], v[220:223], v[32:47]
 buffer_load_dwordx4 v[164:167], v3, s[48:51], s26 offen offset:1024
 buffer_load_dwordx4 v[172:175], v3, s[44:47], s25 offen offset:1024
 v_mfma_f32_32x32x16_bf16 v[48:63], v[212:215], v[216:219], v[48:63]
 v_mfma_f32_32x32x16_bf16 v[64:79], v[212:215], v[220:223], v[64:79]
 s_waitcnt vmcnt(28)
 v_mfma_f32_32x32x16_bf16 v[16:31], v[224:227], v[232:235], v[16:31]
 buffer_load_dwordx4 v[176:179], v3, s[48:51], s26 offen offset:2048
 buffer_load_dwordx4 v[184:187], v3, s[44:47], s25 offen offset:2048
 v_mfma_f32_32x32x16_bf16 v[32:47], v[224:227], v[236:239], v[32:47]
 buffer_load_dwordx4 v[180:183], v3, s[48:51], s26 offen offset:3072
 buffer_load_dwordx4 v[188:191], v3, s[44:47], s25 offen offset:3072
 v_mfma_f32_32x32x16_bf16 v[48:63], v[228:231], v[232:235], v[48:63]
 v_mfma_f32_32x32x16_bf16 v[64:79], v[228:231], v[236:239], v[64:79]
 s_waitcnt vmcnt(28)
 v_mfma_f32_32x32x16_bf16 v[16:31], v[240:243], v[248:251], v[16:31]
 s_add_u32 s25, s25, 4096
 s_add_u32 s26, s26, 4096
 buffer_load_dwordx4 v[192:195], v3, s[48:51], s26 offen offset:0
 buffer_load_dwordx4 v[200:203], v3, s[44:47], s25 offen offset:0
 v_mfma_f32_32x32x16_bf16 v[32:47], v[240:243], v[252:255], v[32:47]
 buffer_load_dwordx4 v[196:199], v3, s[48:51], s26 offen offset:1024
 buffer_load_dwordx4 v[204:207], v3, s[44:47], s25 offen offset:1024
 v_mfma_f32_32x32x16_bf16 v[48:63], v[244:247], v[248:251], v[48:63]
 v_mfma_f32_32x32x16_bf16 v[64:79], v[244:247], v[252:255], v[64:79]
 s_barrier
 s_waitcnt vmcnt(28)
 v_mfma_f32_32x32x16_bf16 v[16:31], v[80:83], v[88:91], v[16:31]
 buffer_load_dwordx4 v[208:211], v3, s[48:51], s26 offen offset:2048
 buffer_load_dwordx4 v[216:219], v3, s[44:47], s25 offen offset:2048
 v_mfma_f32_32x32x16_bf16 v[32:47], v[80:83], v[92:95], v[32:47]
 buffer_load_dwordx4 v[212:215], v3, s[48:51], s26 offen offset:3072
 buffer_load_dwordx4 v[220:223], v3, s[44:47], s25 offen offset:3072
 v_mfma_f32_32x32x16_bf16 v[48:63], v[84:87], v[88:91], v[48:63]
 v_mfma_f32_32x32x16_bf16 v[64:79], v[84:87], v[92:95], v[64:79]
 s_waitcnt vmcnt(28)
 v_mfma_f32_32x32x16_bf16 v[16:31], v[96:99], v[104:107], v[16:31]
 s_add_u32 s25, s25, 4096
 s_add_u32 s26, s26, 4096
 buffer_load_dwordx4 v[224:227], v3, s[48:51], s26 offen offset:0
 buffer_load_dwordx4 v[232:235], v3, s[44:47], s25 offen offset:0
 v_mfma_f32_32x32x16_bf16 v[32:47], v[96:99], v[108:111], v[32:47]
 buffer_load_dwordx4 v[228:231], v3, s[48:51], s26 offen offset:1024
 buffer_load_dwordx4 v[236:239], v3, s[44:47], s25 offen offset:1024
 v_mfma_f32_32x32x16_bf16 v[48:63], v[100:103], v[104:107], v[48:63]
 v_mfma_f32_32x32x16_bf16 v[64:79], v[100:103], v[108:111], v[64:79]
 s_waitcnt vmcnt(28)
 v_mfma_f32_32x32x16_bf16 v[16:31], v[112:115], v[120:123], v[16:31]
 buffer_load_dwordx4 v[240:243], v3, s[48:51], s26 offen offset:2048
 buffer_load_dwordx4 v[248:251], v3, s[44:47], s25 offen offset:2048
 v_mfma_f32_32x32x16_bf16 v[32:47], v[112:115], v[124:127], v[32:47]
 buffer_load_dwordx4 v[244:247], v3, s[48:51], s26 offen offset:3072
 buffer_load_dwordx4 v[252:255], v3, s[44:47], s25 offen offset:3072
 v_mfma_f32_32x32x16_bf16 v[48:63], v[116:119], v[120:123], v[48:63]
 v_mfma_f32_32x32x16_bf16 v[64:79], v[116:119], v[124:127], v[64:79]
 s_waitcnt vmcnt(28)
 v_mfma_f32_32x32x16_bf16 v[16:31], v[128:131], v[136:139], v[16:31]
 s_add_u32 s25, s25, 4096
 s_add_u32 s26, s26, 4096
 buffer_load_dwordx4 v[80:83], v3, s[48:51], s26 offen offset:0
 buffer_load_dwordx4 v[88:91], v3, s[44:47], s25 offen offset:0
 v_mfma_f32_32x32x16_bf16 v[32:47], v[128:131], v[140:143], v[32:47]
 buffer_load_dwordx4 v[84:87], v3, s[48:51], s26 offen offset:1024
 buffer_load_dwordx4 v[92:95], v3, s[44:47], s25 offen offset:1024
 v_mfma_f32_32x32x16_bf16 v[48:63], v[132:135], v[136:139], v[48:63]
 v_mfma_f32_32x32x16_bf16 v[64:79], v[132:135], v[140:143], v[64:79]
 s_waitcnt vmcnt(28)
 v_mfma_f32_32x32x16_bf16 v[16:31], v[144:147], v[152:155], v[16:31]
 buffer_load_dwordx4 v[96:99], v3, s[48:51], s26 offen offset:2048
 buffer_load_dwordx4 v[104:107], v3, s[44:47], s25 offen offset:2048
 v_mfma_f32_32x32x16_bf16 v[32:47], v[144:147], v[156:159], v[32:47]
 buffer_load_dwordx4 v[100:103], v3, s[48:51], s26 offen offset:3072
 buffer_load_dwordx4 v[108:111], v3, s[44:47], s25 offen offset:3072
 v_mfma_f32_32x32x16_bf16 v[48:63], v[148:151], v[152:155], v[48:63]
 v_mfma_f32_32x32x16_bf16 v[64:79], v[148:151], v[156:159], v[64:79]
 s_waitcnt vmcnt(28)
 v_mfma_f32_32x32x16_bf16 v[16:31], v[160:163], v[168:171], v[16:31]
 s_add_u32 s25, s25, 4096
 s_add_u32 s26, s26, 4096
 buffer_load_dwordx4 v[112:115], v3, s[48:51], s26 offen offset:0
 buffer_load_dwordx4 v[120:123], v3, s[44:47], s25 offen offset:0
 v_mfma_f32_32x32x16_bf16 v[32:47], v[160:163], v[172:175], v[32:47]
 buffer_load_dwordx4 v[116:119], v3, s[48:51], s26 offen offset:1024
 buffer_load_dwordx4 v[124:127], v3, s[44:47], s25 offen offset:1024
 v_mfma_f32_32x32x16_bf16 v[48:63], v[164:167], v[168:171], v[48:63]
 v_mfma_f32_32x32x16_bf16 v[64:79], v[164:167], v[172:175], v[64:79]
 s_waitcnt vmcnt(28)
 v_mfma_f32_32x32x16_bf16 v[16:31], v[176:179], v[184:187], v[16:31]
 buffer_load_dwordx4 v[128:131], v3, s[48:51], s26 offen offset:2048
 buffer_load_dwordx4 v[136:139], v3, s[44:47], s25 offen offset:2048
 v_mfma_f32_32x32x16_bf16 v[32:47], v[176:179], v[188:191], v[32:47]
 buffer_load_dwordx4 v[132:135], v3, s[48:51], s26 offen offset:3072
 buffer_load_dwordx4 v[140:143], v3, s[44:47], s25 offen offset:3072
 v_mfma_f32_32x32x16_bf16 v[48:63], v[180:183], v[184:187], v[48:63]
 v_mfma_f32_32x32x16_bf16 v[64:79], v[180:183], v[188:191], v[64:79]
 s_waitcnt vmcnt(28)
 v_mfma_f32_32x32x16_bf16 v[16:31], v[192:195], v[200:203], v[16:31]
 s_add_u32 s25, s25, 4096
 s_add_u32 s26, s26, 4096
 buffer_load_dwordx4 v[144:147], v3, s[48:51], s26 offen offset:0
 buffer_load_dwordx4 v[152:155], v3, s[44:47], s25 offen offset:0
 v_mfma_f32_32x32x16_bf16 v[32:47], v[192:195], v[204:207], v[32:47]
 buffer_load_dwordx4 v[148:151], v3, s[48:51], s26 offen offset:1024
 buffer_load_dwordx4 v[156:159], v3, s[44:47], s25 offen offset:1024
 v_mfma_f32_32x32x16_bf16 v[48:63], v[196:199], v[200:203], v[48:63]
 v_mfma_f32_32x32x16_bf16 v[64:79], v[196:199], v[204:207], v[64:79]
 s_waitcnt vmcnt(28)
 v_mfma_f32_32x32x16_bf16 v[16:31], v[208:211], v[216:219], v[16:31]
 buffer_load_dwordx4 v[160:163], v3, s[48:51], s26 offen offset:2048
 buffer_load_dwordx4 v[168:171], v3, s[44:47], s25 offen offset:2048
 v_mfma_f32_32x32x16_bf16 v[32:47], v[208:211], v[220:223], v[32:47]
 buffer_load_dwordx4 v[164:167], v3, s[48:51], s26 offen offset:3072
 buffer_load_dwordx4 v[172:175], v3, s[44:47], s25 offen offset:3072
 v_mfma_f32_32x32x16_bf16 v[48:63], v[212:215], v[216:219], v[48:63]
 v_mfma_f32_32x32x16_bf16 v[64:79], v[212:215], v[220:223], v[64:79]
 s_waitcnt vmcnt(28)
 v_mfma_f32_32x32x16_bf16 v[16:31], v[224:227], v[232:235], v[16:31]
 v_mfma_f32_32x32x16_bf16 v[32:47], v[224:227], v[236:239], v[32:47]
 v_mfma_f32_32x32x16_bf16 v[48:63], v[228:231], v[232:235], v[48:63]
 v_mfma_f32_32x32x16_bf16 v[64:79], v[228:231], v[236:239], v[64:79]
 s_waitcnt vmcnt(24)
 v_mfma_f32_32x32x16_bf16 v[16:31], v[240:243], v[248:251], v[16:31]
 v_mfma_f32_32x32x16_bf16 v[32:47], v[240:243], v[252:255], v[32:47]
 v_mfma_f32_32x32x16_bf16 v[48:63], v[244:247], v[248:251], v[48:63]
 v_mfma_f32_32x32x16_bf16 v[64:79], v[244:247], v[252:255], v[64:79]
 s_waitcnt vmcnt(20)
 v_mfma_f32_32x32x16_bf16 v[16:31], v[80:83], v[88:91], v[16:31]
 v_mfma_f32_32x32x16_bf16 v[32:47], v[80:83], v[92:95], v[32:47]
 v_mfma_f32_32x32x16_bf16 v[48:63], v[84:87], v[88:91], v[48:63]
 v_mfma_f32_32x32x16_bf16 v[64:79], v[84:87], v[92:95], v[64:79]
 s_waitcnt vmcnt(16)
 v_mfma_f32_32x32x16_bf16 v[16:31], v[96:99], v[104:107], v[16:31]
 v_mfma_f32_32x32x16_bf16 v[32:47], v[96:99], v[108:111], v[32:47]
 v_mfma_f32_32x32x16_bf16 v[48:63], v[100:103], v[104:107], v[48:63]
 v_mfma_f32_32x32x16_bf16 v[64:79], v[100:103], v[108:111], v[64:79]
 s_waitcnt vmcnt(12)
 v_mfma_f32_32x32x16_bf16 v[16:31], v[112:115], v[120:123], v[16:31]
 v_mfma_f32_32x32x16_bf16 v[32:47], v[112:115], v[124:127], v[32:47]
 v_mfma_f32_32x32x16_bf16 v[48:63], v[116:119], v[120:123], v[48:63]
 v_mfma_f32_32x32x16_bf16 v[64:79], v[116:119], v[124:127], v[64:79]
 s_waitcnt vmcnt(8)
 v_mfma_f32_32x32x16_bf16 v[16:31], v[128:131], v[136:139], v[16:31]
 v_mfma_f32_32x32x16_bf16 v[32:47], v[128:131], v[140:143], v[32:47]
 v_mfma_f32_32x32x16_bf16 v[48:63], v[132:135], v[136:139], v[48:63]
 v_mfma_f32_32x32x16_bf16 v[64:79], v[132:135], v[140:143], v[64:79]
 s_waitcnt vmcnt(4)
 v_mfma_f32_32x32x16_bf16 v[16:31], v[144:147], v[152:155], v[16:31]
 v_mfma_f32_32x32x16_bf16 v[32:47], v[144:147], v[156:159], v[32:47]
 v_mfma_f32_32x32x16_bf16 v[48:63], v[148:151], v[152:155], v[48:63]
 v_mfma_f32_32x32x16_bf16 v[64:79], v[148:151], v[156:159], v[64:79]
 s_waitcnt vmcnt(0)
 v_mfma_f32_32x32x16_bf16 v[16:31], v[160:163], v[168:171], v[16:31]
 v_mfma_f32_32x32x16_bf16 v[32:47], v[160:163], v[172:175], v[32:47]
 v_mfma_f32_32x32x16_bf16 v[48:63], v[164:167], v[168:171], v[48:63]
 v_mfma_f32_32x32x16_bf16 v[64:79], v[164:167], v[172:175], v[64:79]
 s_nop 8
 ds_write_b128 v5, v[16:19] offset:0
 ds_write_b128 v5, v[20:23] offset:32
 ds_write_b128 v5, v[24:27] offset:64
 ds_write_b128 v5, v[28:31] offset:96
 ds_write_b128 v5, v[32:35] offset:8704
 ds_write_b128 v5, v[36:39] offset:8736
 ds_write_b128 v5, v[40:43] offset:8768
 ds_write_b128 v5, v[44:47] offset:8800
 ds_write_b128 v5, v[48:51] offset:128
 ds_write_b128 v5, v[52:55] offset:160
 ds_write_b128 v5, v[56:59] offset:192
 ds_write_b128 v5, v[60:63] offset:224
 ds_write_b128 v5, v[64:67] offset:8832
 ds_write_b128 v5, v[68:71] offset:8864
 ds_write_b128 v5, v[72:75] offset:8896
 ds_write_b128 v5, v[76:79] offset:8928
 s_waitcnt lgkmcnt(0)
 s_barrier
 s_endpgm
K2_S:
 s_setprio 3
 s_sub_u32 s29, s20, 4
 s_lshl_b32 s27, s23, 16
 s_lshl_b32 s3, s29, 14
 s_add_u32 s27, s27, s3
 s_mov_b32 s54, 2097152
 s_mov_b32 s55, 0x20000
 s_waitcnt lgkmcnt(0)
 s_add_u32 s52, s18, 10485760
 s_addc_u32 s53, s19, 0
 buffer_load_dwordx4 v[128:131], v3, s[52:55], s27 offen offset:0
 buffer_load_dwordx4 v[132:135], v3, s[52:55], s27 offen offset:1024
 buffer_load_dwordx4 v[136:139], v3, s[52:55], s27 offen offset:2048
 buffer_load_dwordx4 v[140:143], v3, s[52:55], s27 offen offset:3072
 s_add_u32 s27, s27, 4096
 buffer_load_dwordx4 v[144:147], v3, s[52:55], s27 offen offset:0
 buffer_load_dwordx4 v[148:151], v3, s[52:55], s27 offen offset:1024
 buffer_load_dwordx4 v[152:155], v3, s[52:55], s27 offen offset:2048
 buffer_load_dwordx4 v[156:159], v3, s[52:55], s27 offen offset:3072
 s_add_u32 s27, s27, 4096
 buffer_load_dwordx4 v[160:163], v3, s[52:55], s27 offen offset:0
 buffer_load_dwordx4 v[164:167], v3, s[52:55], s27 offen offset:1024
 buffer_load_dwordx4 v[168:171], v3, s[52:55], s27 offen offset:2048
 buffer_load_dwordx4 v[172:175], v3, s[52:55], s27 offen offset:3072
 s_add_u32 s27, s27, 4096
 buffer_load_dwordx4 v[176:179], v3, s[52:55], s27 offen offset:0
 buffer_load_dwordx4 v[180:183], v3, s[52:55], s27 offen offset:1024
 buffer_load_dwordx4 v[184:187], v3, s[52:55], s27 offen offset:2048
 buffer_load_dwordx4 v[188:191], v3, s[52:55], s27 offen offset:3072
 s_mov_b32 s64, s4
 s_mov_b32 s65, s5
 s_mov_b32 s66, 2097152
 s_mov_b32 s67, 0x20000
 s_mov_b32 s68, s6
 s_mov_b32 s69, s7
 s_mov_b32 s70, 2097152
 s_mov_b32 s71, 0x20000
 v_lshrrev_b32 v12, 2, v1
 v_and_b32 v13, 3, v1
 s_lshl_b32 s3, s23, 5
 s_and_b32 s31, s29, 1
 s_lshl_b32 s31, s31, 4
 s_add_u32 s3, s3, s31
 v_add_u32 v4, s3, v12
 s_bitcmp1_b32 s29, 1
 s_cselect_b32 s3, -1, 0
 s_cselect_b32 s31, 0x801, 0
 v_xor_b32 v4, s3, v4
 v_add_u32 v4, s31, v4
 v_mov_b32 v6, 0x400
 v_cmp_eq_u32 vcc, 0x800, v4
 s_nop 1
 v_cndmask_b32 v4, v4, v6, vcc
 v_lshlrev_b32 v4, 10, v4
 v_lshl_add_u32 v4, v13, 5, v4
 s_lshl_b32 s32, s24, 7
 buffer_load_dwordx4 v[192:195], v4, s[64:67], s32 offen
 buffer_load_dwordx4 v[196:199], v4, s[64:67], s32 offen offset:16
 s_setprio 0
 s_lshl_b32 s3, s29, 4
 v_add_u32 v6, s3, v12
 v_mul_u32_u24 v6, 272, v6
 v_lshl_add_u32 v6, v13, 6, v6
 v_add_u32 v7, 34816, v6
 v_add_u32 v8, 69632, v6
 v_add_u32 v9, 104448, v6
 v_and_b32 v15, 31, v1
 v_lshrrev_b32 v16, 5, v1
 v_mul_u32_u24 v5, 272, v15
 v_lshl_add_u32 v5, v16, 4, v5
 s_mul_i32 s35, s20, 17408
 v_add_u32 v5, s35, v5
 s_lshl_b32 s3, s24, 6
 v_add_u32 v10, s3, v15
 v_add_u32 v11, 32, v10
 v_cvt_f32_u32 v10, v10
 v_cvt_f32_u32 v11, v11
 s_lshl_b32 s3, s29, 7
 v_lshl_add_u32 v14, v16, 3, s3
 v_cvt_f32_u32 v14, v14
 v_mul_f32 v10, 0x3b000000, v10
 v_mul_f32 v11, 0x3b000000, v11
 v_mul_f32 v12, v10, v14
 v_mul_f32 v13, v11, v14
 v_fract_f32 v12, v12
 v_fract_f32 v13, v13
 s_cmp_eq_u32 s23, 0
 s_cselect_b32 s30, 1, 0
 s_mov_b32 s31, s30
 v_fmamk_f32 v200, v10, 0x00000000, v12
 v_fmamk_f32 v201, v10, 0x3f800000, v12
 v_fmamk_f32 v202, v10, 0x40000000, v12
 v_fmamk_f32 v203, v10, 0x40400000, v12
 v_fmamk_f32 v204, v10, 0x40800000, v12
 v_fmamk_f32 v205, v10, 0x40a00000, v12
 v_fmamk_f32 v206, v10, 0x40c00000, v12
 v_fmamk_f32 v207, v10, 0x40e00000, v12
 v_sin_f32 v208, v200
 v_sin_f32 v209, v201
 v_sin_f32 v210, v202
 v_sin_f32 v211, v203
 v_sin_f32 v212, v204
 v_sin_f32 v213, v205
 v_sin_f32 v214, v206
 v_sin_f32 v215, v207
 v_cos_f32 v200, v200
 v_cos_f32 v201, v201
 v_cos_f32 v202, v202
 v_cos_f32 v203, v203
 v_cos_f32 v204, v204
 v_cos_f32 v205, v205
 v_cos_f32 v206, v206
 v_cos_f32 v207, v207
 v_cvt_pk_bf16_f32 v220, v208, v209
 v_cvt_pk_bf16_f32 v221, v210, v211
 v_cvt_pk_bf16_f32 v222, v212, v213
 v_cvt_pk_bf16_f32 v223, v214, v215
 v_cvt_pk_bf16_f32 v216, v200, v201
 v_cvt_pk_bf16_f32 v217, v202, v203
 v_cvt_pk_bf16_f32 v218, v204, v205
 v_cvt_pk_bf16_f32 v219, v206, v207
 s_waitcnt vmcnt(16)
 v_mfma_f32_32x32x16_bf16 v[48:63], v[220:223], v[132:135], 0
 v_mfma_f32_32x32x16_bf16 v[16:31], v[216:219], v[128:131], 0
 s_cbranch_scc0 K2_NR1
 v_mfma_f32_32x32x16_bf16 v[80:95], v[216:219], v[132:135], 0
K2_NR1:
 v_fmamk_f32 v224, v11, 0x00000000, v13
 v_fmamk_f32 v225, v11, 0x3f800000, v13
 v_fmamk_f32 v226, v11, 0x40000000, v13
 v_fmamk_f32 v227, v11, 0x40400000, v13
 v_fmamk_f32 v228, v11, 0x40800000, v13
 v_fmamk_f32 v229, v11, 0x40a00000, v13
 v_fmamk_f32 v230, v11, 0x40c00000, v13
 v_fmamk_f32 v231, v11, 0x40e00000, v13
 v_sin_f32 v232, v224
 v_sin_f32 v233, v225
 v_sin_f32 v234, v226
 v_sin_f32 v235, v227
 v_sin_f32 v236, v228
 v_sin_f32 v237, v229
 v_sin_f32 v238, v230
 v_sin_f32 v239, v231
 v_cos_f32 v224, v224
 v_cos_f32 v225, v225
 v_cos_f32 v226, v226
 v_cos_f32 v227, v227
 v_cos_f32 v228, v228
 v_cos_f32 v229, v229
 v_cos_f32 v230, v230
 v_cos_f32 v231, v231
 v_cvt_pk_bf16_f32 v244, v232, v233
 v_cvt_pk_bf16_f32 v245, v234, v235
 v_cvt_pk_bf16_f32 v246, v236, v237
 v_cvt_pk_bf16_f32 v247, v238, v239
 v_cvt_pk_bf16_f32 v240, v224, v225
 v_cvt_pk_bf16_f32 v241, v226, v227
 v_cvt_pk_bf16_f32 v242, v228, v229
 v_cvt_pk_bf16_f32 v243, v230, v231
 v_mfma_f32_32x32x16_bf16 v[64:79], v[244:247], v[132:135], 0
 s_nop 0
 v_mfma_f32_32x32x16_bf16 v[32:47], v[240:243], v[128:131], 0
 s_cbranch_scc0 K2_NR2
 v_mfma_f32_32x32x16_bf16 v[96:111], v[240:243], v[132:135], 0
K2_NR2:
 v_fmamk_f32 v200, v10, 0x41800000, v12
 v_fmamk_f32 v201, v10, 0x41880000, v12
 v_fmamk_f32 v202, v10, 0x41900000, v12
 v_fmamk_f32 v203, v10, 0x41980000, v12
 v_fmamk_f32 v204, v10, 0x41a00000, v12
 v_fmamk_f32 v205, v10, 0x41a80000, v12
 v_fmamk_f32 v206, v10, 0x41b00000, v12
 v_fmamk_f32 v207, v10, 0x41b80000, v12
 v_sin_f32 v208, v200
 v_sin_f32 v209, v201
 v_sin_f32 v210, v202
 v_sin_f32 v211, v203
 v_sin_f32 v212, v204
 v_sin_f32 v213, v205
 v_sin_f32 v214, v206
 v_sin_f32 v215, v207
 v_cos_f32 v200, v200
 v_cos_f32 v201, v201
 v_cos_f32 v202, v202
 v_cos_f32 v203, v203
 v_cos_f32 v204, v204
 v_cos_f32 v205, v205
 v_cos_f32 v206, v206
 v_cos_f32 v207, v207
 v_cvt_pk_bf16_f32 v220, v208, v209
 v_cvt_pk_bf16_f32 v221, v210, v211
 v_cvt_pk_bf16_f32 v222, v212, v213
 v_cvt_pk_bf16_f32 v223, v214, v215
 v_cvt_pk_bf16_f32 v216, v200, v201
 v_cvt_pk_bf16_f32 v217, v202, v203
 v_cvt_pk_bf16_f32 v218, v204, v205
 v_cvt_pk_bf16_f32 v219, v206, v207
 s_waitcnt vmcnt(14)
 v_mfma_f32_32x32x16_bf16 v[48:63], v[220:223], v[140:143], v[48:63]
 v_mfma_f32_32x32x16_bf16 v[16:31], v[216:219], v[136:139], v[16:31]
 s_cbranch_scc0 K2_NR3
 v_mfma_f32_32x32x16_bf16 v[80:95], v[216:219], v[140:143], v[80:95]
K2_NR3:
 v_fmamk_f32 v224, v11, 0x41800000, v13
 v_fmamk_f32 v225, v11, 0x41880000, v13
 v_fmamk_f32 v226, v11, 0x41900000, v13
 v_fmamk_f32 v227, v11, 0x41980000, v13
 v_fmamk_f32 v228, v11, 0x41a00000, v13
 v_fmamk_f32 v229, v11, 0x41a80000, v13
 v_fmamk_f32 v230, v11, 0x41b00000, v13
 v_fmamk_f32 v231, v11, 0x41b80000, v13
 v_sin_f32 v232, v224
 v_sin_f32 v233, v225
 v_sin_f32 v234, v226
 v_sin_f32 v235, v227
 v_sin_f32 v236, v228
 v_sin_f32 v237, v229
 v_sin_f32 v238, v230
 v_sin_f32 v239, v231
 v_cos_f32 v224, v224
 v_cos_f32 v225, v225
 v_cos_f32 v226, v226
 v_cos_f32 v227, v227
 v_cos_f32 v228, v228
 v_cos_f32 v229, v229
 v_cos_f32 v230, v230
 v_cos_f32 v231, v231
 v_cvt_pk_bf16_f32 v244, v232, v233
 v_cvt_pk_bf16_f32 v245, v234, v235
 v_cvt_pk_bf16_f32 v246, v236, v237
 v_cvt_pk_bf16_f32 v247, v238, v239
 v_cvt_pk_bf16_f32 v240, v224, v225
 v_cvt_pk_bf16_f32 v241, v226, v227
 v_cvt_pk_bf16_f32 v242, v228, v229
 v_cvt_pk_bf16_f32 v243, v230, v231
 v_mfma_f32_32x32x16_bf16 v[64:79], v[244:247], v[140:143], v[64:79]
 s_nop 0
 v_mfma_f32_32x32x16_bf16 v[32:47], v[240:243], v[136:139], v[32:47]
 s_cbranch_scc0 K2_NR4
 v_mfma_f32_32x32x16_bf16 v[96:111], v[240:243], v[140:143], v[96:111]
K2_NR4:
 v_fmamk_f32 v200, v10, 0x42000000, v12
 v_fmamk_f32 v201, v10, 0x42040000, v12
 v_fmamk_f32 v202, v10, 0x42080000, v12
 v_fmamk_f32 v203, v10, 0x420c0000, v12
 v_fmamk_f32 v204, v10, 0x42100000, v12
 v_fmamk_f32 v205, v10, 0x42140000, v12
 v_fmamk_f32 v206, v10, 0x42180000, v12
 v_fmamk_f32 v207, v10, 0x421c0000, v12
 v_sin_f32 v208, v200
 v_sin_f32 v209, v201
 v_sin_f32 v210, v202
 v_sin_f32 v211, v203
 v_sin_f32 v212, v204
 v_sin_f32 v213, v205
 v_sin_f32 v214, v206
 v_sin_f32 v215, v207
 v_cos_f32 v200, v200
 v_cos_f32 v201, v201
 v_cos_f32 v202, v202
 v_cos_f32 v203, v203
 v_cos_f32 v204, v204
 v_cos_f32 v205, v205
 v_cos_f32 v206, v206
 v_cos_f32 v207, v207
 v_cvt_pk_bf16_f32 v220, v208, v209
 v_cvt_pk_bf16_f32 v221, v210, v211
 v_cvt_pk_bf16_f32 v222, v212, v213
 v_cvt_pk_bf16_f32 v223, v214, v215
 v_cvt_pk_bf16_f32 v216, v200, v201
 v_cvt_pk_bf16_f32 v217, v202, v203
 v_cvt_pk_bf16_f32 v218, v204, v205
 v_cvt_pk_bf16_f32 v219, v206, v207
 s_waitcnt vmcnt(12)
 v_mfma_f32_32x32x16_bf16 v[48:63], v[220:223], v[148:151], v[48:63]
 v_mfma_f32_32x32x16_bf16 v[16:31], v[216:219], v[144:147], v[16:31]
 s_cbranch_scc0 K2_NR5
 v_mfma_f32_32x32x16_bf16 v[80:95], v[216:219], v[148:151], v[80:95]
K2_NR5:
 v_fmamk_f32 v224, v11, 0x42000000, v13
 v_fmamk_f32 v225, v11, 0x42040000, v13
 v_fmamk_f32 v226, v11, 0x42080000, v13
 v_fmamk_f32 v227, v11, 0x420c0000, v13
 v_fmamk_f32 v228, v11, 0x42100000, v13
 v_fmamk_f32 v229, v11, 0x42140000, v13
 v_fmamk_f32 v230, v11, 0x42180000, v13
 v_fmamk_f32 v231, v11, 0x421c0000, v13
 v_sin_f32 v232, v224
 v_sin_f32 v233, v225
 v_sin_f32 v234, v226
 v_sin_f32 v235, v227
 v_sin_f32 v236, v228
 v_sin_f32 v237, v229
 v_sin_f32 v238, v230
 v_sin_f32 v239, v231
 v_cos_f32 v224, v224
 v_cos_f32 v225, v225
 v_cos_f32 v226, v226
 v_cos_f32 v227, v227
 v_cos_f32 v228, v228
 v_cos_f32 v229, v229
 v_cos_f32 v230, v230
 v_cos_f32 v231, v231
 v_cvt_pk_bf16_f32 v244, v232, v233
 v_cvt_pk_bf16_f32 v245, v234, v235
 v_cvt_pk_bf16_f32 v246, v236, v237
 v_cvt_pk_bf16_f32 v247, v238, v239
 v_cvt_pk_bf16_f32 v240, v224, v225
 v_cvt_pk_bf16_f32 v241, v226, v227
 v_cvt_pk_bf16_f32 v242, v228, v229
 v_cvt_pk_bf16_f32 v243, v230, v231
 v_mfma_f32_32x32x16_bf16 v[64:79], v[244:247], v[148:151], v[64:79]
 s_nop 0
 v_mfma_f32_32x32x16_bf16 v[32:47], v[240:243], v[144:147], v[32:47]
 s_cbranch_scc0 K2_NR6
 v_mfma_f32_32x32x16_bf16 v[96:111], v[240:243], v[148:151], v[96:111]
K2_NR6:
 v_fmamk_f32 v200, v10, 0x42400000, v12
 v_fmamk_f32 v201, v10, 0x42440000, v12
 v_fmamk_f32 v202, v10, 0x42480000, v12
 v_fmamk_f32 v203, v10, 0x424c0000, v12
 v_fmamk_f32 v204, v10, 0x42500000, v12
 v_fmamk_f32 v205, v10, 0x42540000, v12
 v_fmamk_f32 v206, v10, 0x42580000, v12
 v_fmamk_f32 v207, v10, 0x425c0000, v12
 v_sin_f32 v208, v200
 v_sin_f32 v209, v201
 v_sin_f32 v210, v202
 v_sin_f32 v211, v203
 v_sin_f32 v212, v204
 v_sin_f32 v213, v205
 v_sin_f32 v214, v206
 v_sin_f32 v215, v207
 v_cos_f32 v200, v200
 v_cos_f32 v201, v201
 v_cos_f32 v202, v202
 v_cos_f32 v203, v203
 v_cos_f32 v204, v204
 v_cos_f32 v205, v205
 v_cos_f32 v206, v206
 v_cos_f32 v207, v207
 v_cvt_pk_bf16_f32 v220, v208, v209
 v_cvt_pk_bf16_f32 v221, v210, v211
 v_cvt_pk_bf16_f32 v222, v212, v213
 v_cvt_pk_bf16_f32 v223, v214, v215
 v_cvt_pk_bf16_f32 v216, v200, v201
 v_cvt_pk_bf16_f32 v217, v202, v203
 v_cvt_pk_bf16_f32 v218, v204, v205
 v_cvt_pk_bf16_f32 v219, v206, v207
 s_waitcnt vmcnt(10)
 v_mfma_f32_32x32x16_bf16 v[48:63], v[220:223], v[156:159], v[48:63]
 v_mfma_f32_32x32x16_bf16 v[16:31], v[216:219], v[152:155], v[16:31]
 s_cbranch_scc0 K2_NR7
 v_mfma_f32_32x32x16_bf16 v[80:95], v[216:219], v[156:159], v[80:95]
K2_NR7:
 v_fmamk_f32 v224, v11, 0x42400000, v13
 v_fmamk_f32 v225, v11, 0x42440000, v13
 v_fmamk_f32 v226, v11, 0x42480000, v13
 v_fmamk_f32 v227, v11, 0x424c0000, v13
 v_fmamk_f32 v228, v11, 0x42500000, v13
 v_fmamk_f32 v229, v11, 0x42540000, v13
 v_fmamk_f32 v230, v11, 0x42580000, v13
 v_fmamk_f32 v231, v11, 0x425c0000, v13
 v_sin_f32 v232, v224
 v_sin_f32 v233, v225
 v_sin_f32 v234, v226
 v_sin_f32 v235, v227
 v_sin_f32 v236, v228
 v_sin_f32 v237, v229
 v_sin_f32 v238, v230
 v_sin_f32 v239, v231
 v_cos_f32 v224, v224
 v_cos_f32 v225, v225
 v_cos_f32 v226, v226
 v_cos_f32 v227, v227
 v_cos_f32 v228, v228
 v_cos_f32 v229, v229
 v_cos_f32 v230, v230
 v_cos_f32 v231, v231
 v_cvt_pk_bf16_f32 v244, v232, v233
 v_cvt_pk_bf16_f32 v245, v234, v235
 v_cvt_pk_bf16_f32 v246, v236, v237
 v_cvt_pk_bf16_f32 v247, v238, v239
 v_cvt_pk_bf16_f32 v240, v224, v225
 v_cvt_pk_bf16_f32 v241, v226, v227
 v_cvt_pk_bf16_f32 v242, v228, v229
 v_cvt_pk_bf16_f32 v243, v230, v231
 v_mfma_f32_32x32x16_bf16 v[64:79], v[244:247], v[156:159], v[64:79]
 s_nop 0
 v_mfma_f32_32x32x16_bf16 v[32:47], v[240:243], v[152:155], v[32:47]
 s_cbranch_scc0 K2_NR8
 v_mfma_f32_32x32x16_bf16 v[96:111], v[240:243], v[156:159], v[96:111]
K2_NR8:
 v_fmamk_f32 v200, v10, 0x42800000, v12
 v_fmamk_f32 v201, v10, 0x42820000, v12
 v_fmamk_f32 v202, v10, 0x42840000, v12
 v_fmamk_f32 v203, v10, 0x42860000, v12
 v_fmamk_f32 v204, v10, 0x42880000, v12
 v_fmamk_f32 v205, v10, 0x428a0000, v12
 v_fmamk_f32 v206, v10, 0x428c0000, v12
 v_fmamk_f32 v207, v10, 0x428e0000, v12
 v_sin_f32 v208, v200
 v_sin_f32 v209, v201
 v_sin_f32 v210, v202
 v_sin_f32 v211, v203
 v_sin_f32 v212, v204
 v_sin_f32 v213, v205
 v_sin_f32 v214, v206
 v_sin_f32 v215, v207
 v_cos_f32 v200, v200
 v_cos_f32 v201, v201
 v_cos_f32 v202, v202
 v_cos_f32 v203, v203
 v_cos_f32 v204, v204
 v_cos_f32 v205, v205
 v_cos_f32 v206, v206
 v_cos_f32 v207, v207
 v_cvt_pk_bf16_f32 v220, v208, v209
 v_cvt_pk_bf16_f32 v221, v210, v211
 v_cvt_pk_bf16_f32 v222, v212, v213
 v_cvt_pk_bf16_f32 v223, v214, v215
 v_cvt_pk_bf16_f32 v216, v200, v201
 v_cvt_pk_bf16_f32 v217, v202, v203
 v_cvt_pk_bf16_f32 v218, v204, v205
 v_cvt_pk_bf16_f32 v219, v206, v207
 s_waitcnt vmcnt(8)
 v_mfma_f32_32x32x16_bf16 v[48:63], v[220:223], v[164:167], v[48:63]
 v_mfma_f32_32x32x16_bf16 v[16:31], v[216:219], v[160:163], v[16:31]
 s_cbranch_scc0 K2_NR9
 v_mfma_f32_32x32x16_bf16 v[80:95], v[216:219], v[164:167], v[80:95]
K2_NR9:
 v_fmamk_f32 v224, v11, 0x42800000, v13
 v_fmamk_f32 v225, v11, 0x42820000, v13
 v_fmamk_f32 v226, v11, 0x42840000, v13
 v_fmamk_f32 v227, v11, 0x42860000, v13
 v_fmamk_f32 v228, v11, 0x42880000, v13
 v_fmamk_f32 v229, v11, 0x428a0000, v13
 v_fmamk_f32 v230, v11, 0x428c0000, v13
 v_fmamk_f32 v231, v11, 0x428e0000, v13
 v_sin_f32 v232, v224
 v_sin_f32 v233, v225
 v_sin_f32 v234, v226
 v_sin_f32 v235, v227
 v_sin_f32 v236, v228
 v_sin_f32 v237, v229
 v_sin_f32 v238, v230
 v_sin_f32 v239, v231
 v_cos_f32 v224, v224
 v_cos_f32 v225, v225
 v_cos_f32 v226, v226
 v_cos_f32 v227, v227
 v_cos_f32 v228, v228
 v_cos_f32 v229, v229
 v_cos_f32 v230, v230
 v_cos_f32 v231, v231
 v_cvt_pk_bf16_f32 v244, v232, v233
 v_cvt_pk_bf16_f32 v245, v234, v235
 v_cvt_pk_bf16_f32 v246, v236, v237
 v_cvt_pk_bf16_f32 v247, v238, v239
 v_cvt_pk_bf16_f32 v240, v224, v225
 v_cvt_pk_bf16_f32 v241, v226, v227
 v_cvt_pk_bf16_f32 v242, v228, v229
 v_cvt_pk_bf16_f32 v243, v230, v231
 v_mfma_f32_32x32x16_bf16 v[64:79], v[244:247], v[164:167], v[64:79]
 s_nop 0
 v_mfma_f32_32x32x16_bf16 v[32:47], v[240:243], v[160:163], v[32:47]
 s_cbranch_scc0 K2_NR10
 v_mfma_f32_32x32x16_bf16 v[96:111], v[240:243], v[164:167], v[96:111]
K2_NR10:
 v_fmamk_f32 v200, v10, 0x42a00000, v12
 v_fmamk_f32 v201, v10, 0x42a20000, v12
 v_fmamk_f32 v202, v10, 0x42a40000, v12
 v_fmamk_f32 v203, v10, 0x42a60000, v12
 v_fmamk_f32 v204, v10, 0x42a80000, v12
 v_fmamk_f32 v205, v10, 0x42aa0000, v12
 v_fmamk_f32 v206, v10, 0x42ac0000, v12
 v_fmamk_f32 v207, v10, 0x42ae0000, v12
 v_sin_f32 v208, v200
 v_sin_f32 v209, v201
 v_sin_f32 v210, v202
 v_sin_f32 v211, v203
 v_sin_f32 v212, v204
 v_sin_f32 v213, v205
 v_sin_f32 v214, v206
 v_sin_f32 v215, v207
 v_cos_f32 v200, v200
 v_cos_f32 v201, v201
 v_cos_f32 v202, v202
 v_cos_f32 v203, v203
 v_cos_f32 v204, v204
 v_cos_f32 v205, v205
 v_cos_f32 v206, v206
 v_cos_f32 v207, v207
 v_cvt_pk_bf16_f32 v220, v208, v209
 v_cvt_pk_bf16_f32 v221, v210, v211
 v_cvt_pk_bf16_f32 v222, v212, v213
 v_cvt_pk_bf16_f32 v223, v214, v215
 v_cvt_pk_bf16_f32 v216, v200, v201
 v_cvt_pk_bf16_f32 v217, v202, v203
 v_cvt_pk_bf16_f32 v218, v204, v205
 v_cvt_pk_bf16_f32 v219, v206, v207
 s_waitcnt vmcnt(6)
 v_mfma_f32_32x32x16_bf16 v[48:63], v[220:223], v[172:175], v[48:63]
 v_mfma_f32_32x32x16_bf16 v[16:31], v[216:219], v[168:171], v[16:31]
 s_cbranch_scc0 K2_NR11
 v_mfma_f32_32x32x16_bf16 v[80:95], v[216:219], v[172:175], v[80:95]
K2_NR11:
 v_fmamk_f32 v224, v11, 0x42a00000, v13
 v_fmamk_f32 v225, v11, 0x42a20000, v13
 v_fmamk_f32 v226, v11, 0x42a40000, v13
 v_fmamk_f32 v227, v11, 0x42a60000, v13
 v_fmamk_f32 v228, v11, 0x42a80000, v13
 v_fmamk_f32 v229, v11, 0x42aa0000, v13
 v_fmamk_f32 v230, v11, 0x42ac0000, v13
 v_fmamk_f32 v231, v11, 0x42ae0000, v13
 v_sin_f32 v232, v224
 v_sin_f32 v233, v225
 v_sin_f32 v234, v226
 v_sin_f32 v235, v227
 v_sin_f32 v236, v228
 v_sin_f32 v237, v229
 v_sin_f32 v238, v230
 v_sin_f32 v239, v231
 v_cos_f32 v224, v224
 v_cos_f32 v225, v225
 v_cos_f32 v226, v226
 v_cos_f32 v227, v227
 v_cos_f32 v228, v228
 v_cos_f32 v229, v229
 v_cos_f32 v230, v230
 v_cos_f32 v231, v231
 v_cvt_pk_bf16_f32 v244, v232, v233
 v_cvt_pk_bf16_f32 v245, v234, v235
 v_cvt_pk_bf16_f32 v246, v236, v237
 v_cvt_pk_bf16_f32 v247, v238, v239
 v_cvt_pk_bf16_f32 v240, v224, v225
 v_cvt_pk_bf16_f32 v241, v226, v227
 v_cvt_pk_bf16_f32 v242, v228, v229
 v_cvt_pk_bf16_f32 v243, v230, v231
 v_mfma_f32_32x32x16_bf16 v[64:79], v[244:247], v[172:175], v[64:79]
 s_nop 0
 v_mfma_f32_32x32x16_bf16 v[32:47], v[240:243], v[168:171], v[32:47]
 s_cbranch_scc0 K2_NR12
 v_mfma_f32_32x32x16_bf16 v[96:111], v[240:243], v[172:175], v[96:111]
K2_NR12:
 v_fmamk_f32 v200, v10, 0x42c00000, v12
 v_fmamk_f32 v201, v10, 0x42c20000, v12
 v_fmamk_f32 v202, v10, 0x42c40000, v12
 v_fmamk_f32 v203, v10, 0x42c60000, v12
 v_fmamk_f32 v204, v10, 0x42c80000, v12
 v_fmamk_f32 v205, v10, 0x42ca0000, v12
 v_fmamk_f32 v206, v10, 0x42cc0000, v12
 v_fmamk_f32 v207, v10, 0x42ce0000, v12
 v_sin_f32 v208, v200
 v_sin_f32 v209, v201
 v_sin_f32 v210, v202
 v_sin_f32 v211, v203
 v_sin_f32 v212, v204
 v_sin_f32 v213, v205
 v_sin_f32 v214, v206
 v_sin_f32 v215, v207
 v_cos_f32 v200, v200
 v_cos_f32 v201, v201
 v_cos_f32 v202, v202
 v_cos_f32 v203, v203
 v_cos_f32 v204, v204
 v_cos_f32 v205, v205
 v_cos_f32 v206, v206
 v_cos_f32 v207, v207
 v_cvt_pk_bf16_f32 v220, v208, v209
 v_cvt_pk_bf16_f32 v221, v210, v211
 v_cvt_pk_bf16_f32 v222, v212, v213
 v_cvt_pk_bf16_f32 v223, v214, v215
 v_cvt_pk_bf16_f32 v216, v200, v201
 v_cvt_pk_bf16_f32 v217, v202, v203
 v_cvt_pk_bf16_f32 v218, v204, v205
 v_cvt_pk_bf16_f32 v219, v206, v207
 s_waitcnt vmcnt(4)
 v_mfma_f32_32x32x16_bf16 v[48:63], v[220:223], v[180:183], v[48:63]
 v_mfma_f32_32x32x16_bf16 v[16:31], v[216:219], v[176:179], v[16:31]
 s_cbranch_scc0 K2_NR13
 v_mfma_f32_32x32x16_bf16 v[80:95], v[216:219], v[180:183], v[80:95]
K2_NR13:
 v_fmamk_f32 v224, v11, 0x42c00000, v13
 v_fmamk_f32 v225, v11, 0x42c20000, v13
 v_fmamk_f32 v226, v11, 0x42c40000, v13
 v_fmamk_f32 v227, v11, 0x42c60000, v13
 v_fmamk_f32 v228, v11, 0x42c80000, v13
 v_fmamk_f32 v229, v11, 0x42ca0000, v13
 v_fmamk_f32 v230, v11, 0x42cc0000, v13
 v_fmamk_f32 v231, v11, 0x42ce0000, v13
 v_sin_f32 v232, v224
 v_sin_f32 v233, v225
 v_sin_f32 v234, v226
 v_sin_f32 v235, v227
 v_sin_f32 v236, v228
 v_sin_f32 v237, v229
 v_sin_f32 v238, v230
 v_sin_f32 v239, v231
 v_cos_f32 v224, v224
 v_cos_f32 v225, v225
 v_cos_f32 v226, v226
 v_cos_f32 v227, v227
 v_cos_f32 v228, v228
 v_cos_f32 v229, v229
 v_cos_f32 v230, v230
 v_cos_f32 v231, v231
 v_cvt_pk_bf16_f32 v244, v232, v233
 v_cvt_pk_bf16_f32 v245, v234, v235
 v_cvt_pk_bf16_f32 v246, v236, v237
 v_cvt_pk_bf16_f32 v247, v238, v239
 v_cvt_pk_bf16_f32 v240, v224, v225
 v_cvt_pk_bf16_f32 v241, v226, v227
 v_cvt_pk_bf16_f32 v242, v228, v229
 v_cvt_pk_bf16_f32 v243, v230, v231
 v_mfma_f32_32x32x16_bf16 v[64:79], v[244:247], v[180:183], v[64:79]
 s_nop 0
 v_mfma_f32_32x32x16_bf16 v[32:47], v[240:243], v[176:179], v[32:47]
 s_cbranch_scc0 K2_NR14
 v_mfma_f32_32x32x16_bf16 v[96:111], v[240:243], v[180:183], v[96:111]
K2_NR14:
 v_fmamk_f32 v200, v10, 0x42e00000, v12
 v_fmamk_f32 v201, v10, 0x42e20000, v12
 v_fmamk_f32 v202, v10, 0x42e40000, v12
 v_fmamk_f32 v203, v10, 0x42e60000, v12
 v_fmamk_f32 v204, v10, 0x42e80000, v12
 v_fmamk_f32 v205, v10, 0x42ea0000, v12
 v_fmamk_f32 v206, v10, 0x42ec0000, v12
 v_fmamk_f32 v207, v10, 0x42ee0000, v12
 v_sin_f32 v208, v200
 v_sin_f32 v209, v201
 v_sin_f32 v210, v202
 v_sin_f32 v211, v203
 v_sin_f32 v212, v204
 v_sin_f32 v213, v205
 v_sin_f32 v214, v206
 v_sin_f32 v215, v207
 v_cos_f32 v200, v200
 v_cos_f32 v201, v201
 v_cos_f32 v202, v202
 v_cos_f32 v203, v203
 v_cos_f32 v204, v204
 v_cos_f32 v205, v205
 v_cos_f32 v206, v206
 v_cos_f32 v207, v207
 v_cvt_pk_bf16_f32 v220, v208, v209
 v_cvt_pk_bf16_f32 v221, v210, v211
 v_cvt_pk_bf16_f32 v222, v212, v213
 v_cvt_pk_bf16_f32 v223, v214, v215
 v_cvt_pk_bf16_f32 v216, v200, v201
 v_cvt_pk_bf16_f32 v217, v202, v203
 v_cvt_pk_bf16_f32 v218, v204, v205
 v_cvt_pk_bf16_f32 v219, v206, v207
 s_waitcnt vmcnt(2)
 v_mfma_f32_32x32x16_bf16 v[48:63], v[220:223], v[188:191], v[48:63]
 v_mfma_f32_32x32x16_bf16 v[16:31], v[216:219], v[184:187], v[16:31]
 s_cbranch_scc0 K2_NR15
 v_mfma_f32_32x32x16_bf16 v[80:95], v[216:219], v[188:191], v[80:95]
K2_NR15:
 v_fmamk_f32 v224, v11, 0x42e00000, v13
 v_fmamk_f32 v225, v11, 0x42e20000, v13
 v_fmamk_f32 v226, v11, 0x42e40000, v13
 v_fmamk_f32 v227, v11, 0x42e60000, v13
 v_fmamk_f32 v228, v11, 0x42e80000, v13
 v_fmamk_f32 v229, v11, 0x42ea0000, v13
 v_fmamk_f32 v230, v11, 0x42ec0000, v13
 v_fmamk_f32 v231, v11, 0x42ee0000, v13
 v_sin_f32 v232, v224
 v_sin_f32 v233, v225
 v_sin_f32 v234, v226
 v_sin_f32 v235, v227
 v_sin_f32 v236, v228
 v_sin_f32 v237, v229
 v_sin_f32 v238, v230
 v_sin_f32 v239, v231
 v_cos_f32 v224, v224
 v_cos_f32 v225, v225
 v_cos_f32 v226, v226
 v_cos_f32 v227, v227
 v_cos_f32 v228, v228
 v_cos_f32 v229, v229
 v_cos_f32 v230, v230
 v_cos_f32 v231, v231
 v_cvt_pk_bf16_f32 v244, v232, v233
 v_cvt_pk_bf16_f32 v245, v234, v235
 v_cvt_pk_bf16_f32 v246, v236, v237
 v_cvt_pk_bf16_f32 v247, v238, v239
 v_cvt_pk_bf16_f32 v240, v224, v225
 v_cvt_pk_bf16_f32 v241, v226, v227
 v_cvt_pk_bf16_f32 v242, v228, v229
 v_cvt_pk_bf16_f32 v243, v230, v231
 v_mfma_f32_32x32x16_bf16 v[64:79], v[244:247], v[188:191], v[64:79]
 s_nop 0
 v_mfma_f32_32x32x16_bf16 v[32:47], v[240:243], v[184:187], v[32:47]
 s_cbranch_scc0 K2_NR16
 v_mfma_f32_32x32x16_bf16 v[96:111], v[240:243], v[188:191], v[96:111]
K2_NR16:
 s_nop 7
 s_nop 7
 v_cndmask_b32 v48, v48, 0, s[30:31]
 v_cndmask_b32 v80, v16, v80, s[30:31]
 v_cndmask_b32 v49, v49, 0, s[30:31]
 v_cndmask_b32 v81, v17, v81, s[30:31]
 v_cndmask_b32 v50, v50, 0, s[30:31]
 v_cndmask_b32 v82, v18, v82, s[30:31]
 v_cndmask_b32 v51, v51, 0, s[30:31]
 v_cndmask_b32 v83, v19, v83, s[30:31]
 v_cndmask_b32 v52, v52, 0, s[30:31]
 v_cndmask_b32 v84, v20, v84, s[30:31]
 v_cndmask_b32 v53, v53, 0, s[30:31]
 v_cndmask_b32 v85, v21, v85, s[30:31]
 v_cndmask_b32 v54, v54, 0, s[30:31]
 v_cndmask_b32 v86, v22, v86, s[30:31]
 v_cndmask_b32 v55, v55, 0, s[30:31]
 v_cndmask_b32 v87, v23, v87, s[30:31]
 v_cndmask_b32 v56, v56, 0, s[30:31]
 v_cndmask_b32 v88, v24, v88, s[30:31]
 v_cndmask_b32 v57, v57, 0, s[30:31]
 v_cndmask_b32 v89, v25, v89, s[30:31]
 v_cndmask_b32 v58, v58, 0, s[30:31]
 v_cndmask_b32 v90, v26, v90, s[30:31]
 v_cndmask_b32 v59, v59, 0, s[30:31]
 v_cndmask_b32 v91, v27, v91, s[30:31]
 v_cndmask_b32 v60, v60, 0, s[30:31]
 v_cndmask_b32 v92, v28, v92, s[30:31]
 v_cndmask_b32 v61, v61, 0, s[30:31]
 v_cndmask_b32 v93, v29, v93, s[30:31]
 v_cndmask_b32 v62, v62, 0, s[30:31]
 v_cndmask_b32 v94, v30, v94, s[30:31]
 v_cndmask_b32 v63, v63, 0, s[30:31]
 v_cndmask_b32 v95, v31, v95, s[30:31]
 v_add_f32 v16, v16, v48
 v_sub_f32 v80, v80, v48
 v_add_f32 v17, v17, v49
 v_sub_f32 v81, v81, v49
 v_add_f32 v18, v18, v50
 v_sub_f32 v82, v82, v50
 v_add_f32 v19, v19, v51
 v_sub_f32 v83, v83, v51
 v_add_f32 v20, v20, v52
 v_sub_f32 v84, v84, v52
 v_add_f32 v21, v21, v53
 v_sub_f32 v85, v85, v53
 v_add_f32 v22, v22, v54
 v_sub_f32 v86, v86, v54
 v_add_f32 v23, v23, v55
 v_sub_f32 v87, v87, v55
 v_add_f32 v24, v24, v56
 v_sub_f32 v88, v88, v56
 v_add_f32 v25, v25, v57
 v_sub_f32 v89, v89, v57
 v_add_f32 v26, v26, v58
 v_sub_f32 v90, v90, v58
 v_add_f32 v27, v27, v59
 v_sub_f32 v91, v91, v59
 v_add_f32 v28, v28, v60
 v_sub_f32 v92, v92, v60
 v_add_f32 v29, v29, v61
 v_sub_f32 v93, v93, v61
 v_add_f32 v30, v30, v62
 v_sub_f32 v94, v94, v62
 v_add_f32 v31, v31, v63
 v_sub_f32 v95, v95, v63
 ds_write_b128 v5, v[16:19] offset:0
 ds_write_b128 v5, v[20:23] offset:32
 ds_write_b128 v5, v[24:27] offset:64
 ds_write_b128 v5, v[28:31] offset:96
 ds_write_b128 v5, v[80:83] offset:8704
 ds_write_b128 v5, v[84:87] offset:8736
 ds_write_b128 v5, v[88:91] offset:8768
 ds_write_b128 v5, v[92:95] offset:8800
 v_cndmask_b32 v64, v64, 0, s[30:31]
 v_cndmask_b32 v96, v32, v96, s[30:31]
 v_cndmask_b32 v65, v65, 0, s[30:31]
 v_cndmask_b32 v97, v33, v97, s[30:31]
 v_cndmask_b32 v66, v66, 0, s[30:31]
 v_cndmask_b32 v98, v34, v98, s[30:31]
 v_cndmask_b32 v67, v67, 0, s[30:31]
 v_cndmask_b32 v99, v35, v99, s[30:31]
 v_cndmask_b32 v68, v68, 0, s[30:31]
 v_cndmask_b32 v100, v36, v100, s[30:31]
 v_cndmask_b32 v69, v69, 0, s[30:31]
 v_cndmask_b32 v101, v37, v101, s[30:31]
 v_cndmask_b32 v70, v70, 0, s[30:31]
 v_cndmask_b32 v102, v38, v102, s[30:31]
 v_cndmask_b32 v71, v71, 0, s[30:31]
 v_cndmask_b32 v103, v39, v103, s[30:31]
 v_cndmask_b32 v72, v72, 0, s[30:31]
 v_cndmask_b32 v104, v40, v104, s[30:31]
 v_cndmask_b32 v73, v73, 0, s[30:31]
 v_cndmask_b32 v105, v41, v105, s[30:31]
 v_cndmask_b32 v74, v74, 0, s[30:31]
 v_cndmask_b32 v106, v42, v106, s[30:31]
 v_cndmask_b32 v75, v75, 0, s[30:31]
 v_cndmask_b32 v107, v43, v107, s[30:31]
 v_cndmask_b32 v76, v76, 0, s[30:31]
 v_cndmask_b32 v108, v44, v108, s[30:31]
 v_cndmask_b32 v77, v77, 0, s[30:31]
 v_cndmask_b32 v109, v45, v109, s[30:31]
 v_cndmask_b32 v78, v78, 0, s[30:31]
 v_cndmask_b32 v110, v46, v110, s[30:31]
 v_cndmask_b32 v79, v79, 0, s[30:31]
 v_cndmask_b32 v111, v47, v111, s[30:31]
 v_add_f32 v32, v32, v64
 v_sub_f32 v96, v96, v64
 v_add_f32 v33, v33, v65
 v_sub_f32 v97, v97, v65
 v_add_f32 v34, v34, v66
 v_sub_f32 v98, v98, v66
 v_add_f32 v35, v35, v67
 v_sub_f32 v99, v99, v67
 v_add_f32 v36, v36, v68
 v_sub_f32 v100, v100, v68
 v_add_f32 v37, v37, v69
 v_sub_f32 v101, v101, v69
 v_add_f32 v38, v38, v70
 v_sub_f32 v102, v102, v70
 v_add_f32 v39, v39, v71
 v_sub_f32 v103, v103, v71
 v_add_f32 v40, v40, v72
 v_sub_f32 v104, v104, v72
 v_add_f32 v41, v41, v73
 v_sub_f32 v105, v105, v73
 v_add_f32 v42, v42, v74
 v_sub_f32 v106, v106, v74
 v_add_f32 v43, v43, v75
 v_sub_f32 v107, v107, v75
 v_add_f32 v44, v44, v76
 v_sub_f32 v108, v108, v76
 v_add_f32 v45, v45, v77
 v_sub_f32 v109, v109, v77
 v_add_f32 v46, v46, v78
 v_sub_f32 v110, v110, v78
 v_add_f32 v47, v47, v79
 v_sub_f32 v111, v111, v79
 ds_write_b128 v5, v[32:35] offset:128
 ds_write_b128 v5, v[36:39] offset:160
 ds_write_b128 v5, v[40:43] offset:192
 ds_write_b128 v5, v[44:47] offset:224
 ds_write_b128 v5, v[96:99] offset:8832
 ds_write_b128 v5, v[100:103] offset:8864
 ds_write_b128 v5, v[104:107] offset:8896
 ds_write_b128 v5, v[108:111] offset:8928
 s_waitcnt lgkmcnt(0)
 s_barrier
 s_waitcnt vmcnt(0)
 v_lshlrev_b32 v16, 16, v192
 v_and_b32 v17, 0xffff0000, v192
 v_lshlrev_b32 v18, 16, v193
 v_and_b32 v19, 0xffff0000, v193
 v_lshlrev_b32 v20, 16, v194
 v_and_b32 v21, 0xffff0000, v194
 v_lshlrev_b32 v22, 16, v195
 v_and_b32 v23, 0xffff0000, v195
 v_lshlrev_b32 v24, 16, v196
 v_and_b32 v25, 0xffff0000, v196
 v_lshlrev_b32 v26, 16, v197
 v_and_b32 v27, 0xffff0000, v197
 v_lshlrev_b32 v28, 16, v198
 v_and_b32 v29, 0xffff0000, v198
 v_lshlrev_b32 v30, 16, v199
 v_and_b32 v31, 0xffff0000, v199
 ds_read_b128 v[32:35], v8 offset:0
 ds_read_b128 v[36:39], v8 offset:16
 ds_read_b128 v[40:43], v8 offset:32
 ds_read_b128 v[44:47], v8 offset:48
 ds_read_b128 v[48:51], v8 offset:17408
 ds_read_b128 v[52:55], v8 offset:17424
 ds_read_b128 v[56:59], v8 offset:17440
 ds_read_b128 v[60:63], v8 offset:17456
 ds_read_b128 v[64:67], v9 offset:0
 ds_read_b128 v[68:71], v9 offset:16
 ds_read_b128 v[72:75], v9 offset:32
 ds_read_b128 v[76:79], v9 offset:48
 ds_read_b128 v[80:83], v9 offset:17408
 ds_read_b128 v[84:87], v9 offset:17424
 ds_read_b128 v[88:91], v9 offset:17440
 s_waitcnt lgkmcnt(11)
 ds_read_b128 v[92:95], v9 offset:17456
 s_waitcnt lgkmcnt(8)
 v_pk_add_f32 v[32:33], v[32:33], v[48:49]
 v_pk_add_f32 v[34:35], v[34:35], v[50:51]
 v_pk_add_f32 v[36:37], v[36:37], v[52:53]
 v_pk_add_f32 v[38:39], v[38:39], v[54:55]
 v_pk_add_f32 v[40:41], v[40:41], v[56:57]
 v_pk_add_f32 v[42:43], v[42:43], v[58:59]
 v_pk_add_f32 v[44:45], v[44:45], v[60:61]
 v_pk_add_f32 v[46:47], v[46:47], v[62:63]
 v_pk_add_f32 v[16:17], v[16:17], v[32:33]
 v_pk_add_f32 v[18:19], v[18:19], v[34:35]
 v_pk_add_f32 v[20:21], v[20:21], v[36:37]
 v_pk_add_f32 v[22:23], v[22:23], v[38:39]
 v_pk_add_f32 v[24:25], v[24:25], v[40:41]
 v_pk_add_f32 v[26:27], v[26:27], v[42:43]
 v_pk_add_f32 v[28:29], v[28:29], v[44:45]
 v_pk_add_f32 v[30:31], v[30:31], v[46:47]
 s_waitcnt lgkmcnt(0)
 v_pk_add_f32 v[64:65], v[64:65], v[80:81]
 v_pk_add_f32 v[66:67], v[66:67], v[82:83]
 v_pk_add_f32 v[68:69], v[68:69], v[84:85]
 v_pk_add_f32 v[70:71], v[70:71], v[86:87]
 v_pk_add_f32 v[72:73], v[72:73], v[88:89]
 v_pk_add_f32 v[74:75], v[74:75], v[90:91]
 v_pk_add_f32 v[76:77], v[76:77], v[92:93]
 v_pk_add_f32 v[78:79], v[78:79], v[94:95]
 v_pk_add_f32 v[16:17], v[16:17], v[64:65]
 v_pk_add_f32 v[18:19], v[18:19], v[66:67]
 v_pk_add_f32 v[20:21], v[20:21], v[68:69]
 v_pk_add_f32 v[22:23], v[22:23], v[70:71]
 v_pk_add_f32 v[24:25], v[24:25], v[72:73]
 v_pk_add_f32 v[26:27], v[26:27], v[74:75]
 v_pk_add_f32 v[28:29], v[28:29], v[76:77]
 v_pk_add_f32 v[30:31], v[30:31], v[78:79]
 s_barrier
 ds_read_b128 v[32:35], v6 offset:0
 ds_read_b128 v[36:39], v6 offset:16
 ds_read_b128 v[40:43], v6 offset:32
 ds_read_b128 v[44:47], v6 offset:48
 ds_read_b128 v[48:51], v6 offset:17408
 ds_read_b128 v[52:55], v6 offset:17424
 ds_read_b128 v[56:59], v6 offset:17440
 ds_read_b128 v[60:63], v6 offset:17456
 ds_read_b128 v[64:67], v7 offset:0
 ds_read_b128 v[68:71], v7 offset:16
 ds_read_b128 v[72:75], v7 offset:32
 ds_read_b128 v[76:79], v7 offset:48
 ds_read_b128 v[80:83], v7 offset:17408
 ds_read_b128 v[84:87], v7 offset:17424
 ds_read_b128 v[88:91], v7 offset:17440
 s_waitcnt lgkmcnt(11)
 ds_read_b128 v[92:95], v7 offset:17456
 s_waitcnt lgkmcnt(8)
 v_pk_add_f32 v[32:33], v[32:33], v[48:49]
 v_pk_add_f32 v[34:35], v[34:35], v[50:51]
 v_pk_add_f32 v[36:37], v[36:37], v[52:53]
 v_pk_add_f32 v[38:39], v[38:39], v[54:55]
 v_pk_add_f32 v[40:41], v[40:41], v[56:57]
 v_pk_add_f32 v[42:43], v[42:43], v[58:59]
 v_pk_add_f32 v[44:45], v[44:45], v[60:61]
 v_pk_add_f32 v[46:47], v[46:47], v[62:63]
 v_pk_add_f32 v[16:17], v[16:17], v[32:33]
 v_pk_add_f32 v[18:19], v[18:19], v[34:35]
 v_pk_add_f32 v[20:21], v[20:21], v[36:37]
 v_pk_add_f32 v[22:23], v[22:23], v[38:39]
 v_pk_add_f32 v[24:25], v[24:25], v[40:41]
 v_pk_add_f32 v[26:27], v[26:27], v[42:43]
 v_pk_add_f32 v[28:29], v[28:29], v[44:45]
 v_pk_add_f32 v[30:31], v[30:31], v[46:47]
 s_waitcnt lgkmcnt(0)
 v_pk_add_f32 v[64:65], v[64:65], v[80:81]
 v_pk_add_f32 v[66:67], v[66:67], v[82:83]
 v_pk_add_f32 v[68:69], v[68:69], v[84:85]
 v_pk_add_f32 v[70:71], v[70:71], v[86:87]
 v_pk_add_f32 v[72:73], v[72:73], v[88:89]
 v_pk_add_f32 v[74:75], v[74:75], v[90:91]
 v_pk_add_f32 v[76:77], v[76:77], v[92:93]
 v_pk_add_f32 v[78:79], v[78:79], v[94:95]
 v_pk_add_f32 v[16:17], v[16:17], v[64:65]
 v_pk_add_f32 v[18:19], v[18:19], v[66:67]
 v_pk_add_f32 v[20:21], v[20:21], v[68:69]
 v_pk_add_f32 v[22:23], v[22:23], v[70:71]
 v_pk_add_f32 v[24:25], v[24:25], v[72:73]
 v_pk_add_f32 v[26:27], v[26:27], v[74:75]
 v_pk_add_f32 v[28:29], v[28:29], v[76:77]
 v_pk_add_f32 v[30:31], v[30:31], v[78:79]
 v_cvt_pk_bf16_f32 v96, v16, v17
 v_cvt_pk_bf16_f32 v97, v18, v19
 v_cvt_pk_bf16_f32 v98, v20, v21
 v_cvt_pk_bf16_f32 v99, v22, v23
 v_cvt_pk_bf16_f32 v100, v24, v25
 v_cvt_pk_bf16_f32 v101, v26, v27
 v_cvt_pk_bf16_f32 v102, v28, v29
 v_cvt_pk_bf16_f32 v103, v30, v31
 buffer_store_dwordx4 v[96:99], v4, s[68:71], s32 offen
 buffer_store_dwordx4 v[100:103], v4, s[68:71], s32 offen offset:16
K2_END:
 s_endpgm
.section .rodata,"a"
.p2align 6
.amdhsa_kernel fnet_g1_kernel
  .amdhsa_next_free_vgpr 244
  .amdhsa_next_free_sgpr 102
  .amdhsa_accum_offset 244
  .amdhsa_group_segment_fixed_size 0
  .amdhsa_kernarg_size 96
  .amdhsa_user_sgpr_count 2
  .amdhsa_user_sgpr_kernarg_segment_ptr 1
  .amdhsa_system_sgpr_workgroup_id_x 1
.end_amdhsa_kernel
.p2align 6
.amdhsa_kernel fnet_g2_kernel
  .amdhsa_next_free_vgpr 256
  .amdhsa_next_free_sgpr 102
  .amdhsa_accum_offset 256
  .amdhsa_group_segment_fixed_size 0
  .amdhsa_kernarg_size 96
  .amdhsa_user_sgpr_count 2
  .amdhsa_user_sgpr_kernarg_segment_ptr 1
  .amdhsa_system_sgpr_workgroup_id_x 1
.end_amdhsa_kernel
```
